```python
import torch

def _softmax(x, axis=-1):
    return torch.softmax(x, dim=axis)
def _gelu(x):
    return torch.nn.functional.gelu(x, approximate="tanh")
def _silu(x):
    return torch.nn.functional.silu(x)
def _sigmoid(x):
    return torch.sigmoid(x)
def _layernorm(x, axis=-1, eps=1e-5):
    m = x.mean(dim=axis, keepdim=True)
    v = x.var(dim=axis, keepdim=True, unbiased=False)
    return (x - m) / torch.sqrt(v + eps)
def _scatter_add(tgt, idx, src, axis=0):
    return tgt.clone().index_add_(axis, idx, src)
def _segment_sum(src, seg, n):
    out = torch.zeros((n,) + src.shape[1:], dtype=src.dtype)
    return out.index_add_(0, seg, src)
def _pad(x, pw):
    flat = tuple(v for pair in reversed(pw) for v in pair)
    return torch.nn.functional.pad(x, flat)

kernel_name = 'concat_heads__mha_block_cached__mha_block_cached__near_ridge'

def setup_inputs():

    _w = (lambda a: (lambda t: t.to(torch.bfloat16) if t.is_floating_point() else t)(torch.as_tensor(a)))
    def _A_setup():
        B, Sq, D = 8, 96, 448
        H, Sk, Dh = 16, 512, 256
        return {
            "x": _w((lambda *s: torch.randn(*s, dtype=torch.bfloat16) * 0.8)(B, Sq, D)),
            "k_cache": _w((lambda *s: torch.randn(*s, dtype=torch.bfloat16) * 0.8)(B, H, Sk, Dh)),
            "v_cache": _w((lambda *s: torch.randn(*s, dtype=torch.bfloat16) * 0.05)(B, H, Sk, Dh)),
            "wq": _w((lambda *s: torch.randn(*s, dtype=torch.bfloat16) * 0.8)(D, H * Dh) * (D ** -0.5)),
            "wo": _w((lambda *s: torch.randn(*s, dtype=torch.bfloat16) * 0.05)(H * Dh, D) * ((H * Dh) ** -0.5)),
        }
    _A_in = _A_setup()

    def _B_setup():
        B, Sq, D = 8, 96, 448
        H, Sk, Dh = 16, 512, 256
        return {
            "x": _w((lambda *s: torch.randn(*s, dtype=torch.bfloat16) * 0.8)(B, Sq, D)),
            "k_cache": _w((lambda *s: torch.randn(*s, dtype=torch.bfloat16) * 0.8)(B, H, Sk, Dh)),
            "v_cache": _w((lambda *s: torch.randn(*s, dtype=torch.bfloat16) * 0.05)(B, H, Sk, Dh)),
            "wq": _w((lambda *s: torch.randn(*s, dtype=torch.bfloat16) * 0.8)(D, H * Dh) * (D ** -0.5)),
            "wo": _w((lambda *s: torch.randn(*s, dtype=torch.bfloat16) * 0.05)(H * Dh, D) * ((H * Dh) ** -0.5)),
        }
    _B_in = _B_setup()

    return {
        "A_x": _A_in["x"],
        "A_k_cache": _A_in["k_cache"],
        "A_v_cache": _A_in["v_cache"],
        "A_wq": _A_in["wq"],
        "A_wo": _A_in["wo"],
        "B_x": _B_in["x"],
        "B_k_cache": _B_in["k_cache"],
        "B_v_cache": _B_in["v_cache"],
        "B_wq": _B_in["wq"],
        "B_wo": _B_in["wo"],
    }

def reference(A_x, A_k_cache, A_v_cache, A_wq, A_wo, B_x, B_k_cache, B_v_cache, B_wq, B_wo):
    def _A_ref(x, k_cache, v_cache, wq, wo):
        B, Sq, D = x.shape
        H, Dh = 16, 256
        q = (lambda x, *d: x.permute(*d))((x @ wq).reshape(B, Sq, H, Dh), 0, 2, 1, 3)
        scores = torch.einsum("bhqd,bhkd->bhqk", q, k_cache) * (Dh ** -0.5)
        p = _softmax(scores, axis=-1)
        o = torch.einsum("bhqk,bhkd->bhqd", p, v_cache)
        return (lambda x, *d: x.permute(*d))(o, 0, 2, 1, 3).reshape(B, Sq, H * Dh) @ wo

    def _B_ref(x, k_cache, v_cache, wq, wo):
        B, Sq, D = x.shape
        H, Dh = 16, 256
        q = (lambda x, *d: x.permute(*d))((x @ wq).reshape(B, Sq, H, Dh), 0, 2, 1, 3)
        scores = torch.einsum("bhqd,bhkd->bhqk", q, k_cache) * (Dh ** -0.5)
        p = _softmax(scores, axis=-1)
        o = torch.einsum("bhqk,bhkd->bhqd", p, v_cache)
        return (lambda x, *d: x.permute(*d))(o, 0, 2, 1, 3).reshape(B, Sq, H * Dh) @ wo

    a = _A_ref(A_x, A_k_cache, A_v_cache, A_wq, A_wo)
    b = _B_ref(B_x, B_k_cache, B_v_cache, B_wq, B_wo)
    return torch.concatenate([a, b], axis=-1)
```

```asm
; @launch grid=(256,1,1) block=(512,1,1) lds=163840
.amdgcn_target "amdgcn-amd-amdhsa--gfx950"
.text
.globl concat_heads__mha_block_cached__mha_block_cached__near_ridge_kernel
.p2align 8
.type concat_heads__mha_block_cached__mha_block_cached__near_ridge_kernel,@function
concat_heads__mha_block_cached__mha_block_cached__near_ridge_kernel:
    s_cmp_ge_u32 s2, 256
    s_cbranch_scc1 L_end
    s_lshr_b32 s5, s2, 2
    s_and_b32 s5, s5, 1
    s_mul_i32 s3, s5, 40
    s_add_u32 s48, s0, s3
    s_addc_u32 s49, s1, 0
    s_load_dwordx8 s[32:39], s[48:49], 0
    s_load_dwordx2 s[40:41], s[48:49], 32
    s_load_dwordx4 s[60:63], s[0:1], 80
    s_load_dwordx2 s[42:43], s[0:1], 96
    s_getpc_b64 s[50:51]
L_pc:
    v_lshlrev_b32 v1, 7, v0
    v_min_u32 v1, 0x7620, v1
    global_load_dword v191, v1, s[50:51]
    v_lshrrev_b32 v1, 6, v0
    v_and_b32 v2, 63, v0
    v_readfirstlane_b32 s4, v1
    s_and_b32 s7, s2, 3
    s_lshr_b32 s3, s2, 3
    s_and_b32 s3, s3, 3
    s_lshl_b32 s3, s3, 2
    s_add_u32 s7, s7, s3
    s_lshr_b32 s6, s2, 5
    v_lshrrev_b32 v3, 5, v2
    v_and_b32 v4, 31, v2
    v_lshrrev_b32 v5, 4, v2
    v_add_u32 v28, 0, v3
    v_lshlrev_b32 v28, 1, v28
    v_xor_b32 v28, v28, v4
    v_lshlrev_b32 v28, 4, v28
    v_add_u32 v29, 2, v3
    v_lshlrev_b32 v29, 1, v29
    v_xor_b32 v29, v29, v4
    v_lshlrev_b32 v29, 4, v29
    v_lshl_add_u32 v6, v1, 2, v3
    v_and_b32 v7, 2, v1
    v_lshlrev_b32 v7, 6, v7
    v_xor_b32 v12, v28, v7
    v_lshl_add_u32 v12, v6, 13, v12
    v_xor_b32 v13, v29, v7
    v_lshl_add_u32 v13, v6, 13, v13
    v_add_u32 v13, 15360, v13
    v_and_b32 v7, 1, v1
    v_lshlrev_b32 v7, 7, v7
    v_xor_b32 v28, v28, v7
    v_lshl_add_u32 v28, v6, 9, v28
    v_xor_b32 v29, v29, v7
    v_lshl_add_u32 v29, v6, 9, v29
    v_mul_u32_u24 v7, 3, v1
    v_add_u32 v15, v7, v5
    v_lshrrev_b32 v16, 1, v15
    v_and_b32 v16, 1, v16
    v_xor_b32 v14, v15, v16
    v_and_b32 v14, 1, v14
    v_lshl_or_b32 v14, v14, 1, v16
    v_xor_b32 v14, v14, v2
    v_and_b32 v14, 3, v14
    v_lshlrev_b32 v14, 4, v14
    v_lshrrev_b32 v6, 2, v2
    v_lshl_add_u32 v6, v7, 2, v6
    v_mul_u32_u24 v6, 896, v6
    v_add_u32 v14, v14, v6
    s_lshl_b32 s47, s4, 11
    s_mul_i32 s52, s4, 768
    s_add_u32 s52, s52, 65536
    s_lshl_b32 s45, s4, 12
    s_lshl_b32 s55, s4, 15
    s_mov_b32 s10, 86016
    s_mov_b32 s11, 0x20000
    s_mov_b32 s14, 3662336
    s_mov_b32 s15, 0x20000
    s_mov_b32 s18, 262144
    s_mov_b32 s19, 0x20000
    s_mul_i32 s56, s6, 86016
    s_lshl_b32 s57, s7, 9
    s_lshl_b32 s44, s6, 4
    s_add_u32 s44, s44, s7
    s_lshl_b32 s46, s44, 18
    s_lshr_b32 s58, s6, 1
    s_lshr_b32 s3, s7, 2
    s_add_u32 s58, s58, s3
    s_and_b32 s58, s58, 3
    s_mul_i32 s58, s58, 7
    s_lshr_b32 s58, s58, 1
    s_lshl_b32 s59, s6, 1
    v_lshrrev_b32 v6, 3, v2
    v_and_b32 v7, 7, v2
    v_xor_b32 v8, v5, v7
    v_lshlrev_b32 v8, 4, v8
    v_lshl_add_u32 v8, v6, 9, v8
    v_xor_b32 v9, 4, v5
    v_xor_b32 v9, v9, v7
    v_lshlrev_b32 v9, 4, v9
    v_lshl_add_u32 v9, v6, 9, v9
    v_add_u32 v9, 3072, v9
    v_xor_b32 v10, v5, v7
    v_lshlrev_b32 v10, 4, v10
    v_lshl_add_u32 v10, v6, 9, v10
    v_add_u32 v10, 6144, v10
    v_xor_b32 v11, 4, v5
    v_xor_b32 v11, v11, v7
    v_lshlrev_b32 v11, 4, v11
    v_lshl_add_u32 v11, v6, 9, v11
    v_add_u32 v11, 9216, v11
    s_waitcnt lgkmcnt(0)
    s_add_u32 s8, s32, s56
    s_addc_u32 s9, s33, 0
    s_add_u32 s12, s38, s57
    s_addc_u32 s13, s39, 0
    s_add_u32 s16, s34, s46
    s_addc_u32 s17, s35, 0
    s_bitcmp1_b32 s2, 5
    s_cbranch_scc1 L_first2
    s_add_u32 m0, s52, 0
    s_lshl_b32 s53, s58, 6
    s_mov_b32 exec_hi, 0xffff
    buffer_load_dwordx4 v14, s[8:11], s53 offen lds
    s_mov_b32 exec_hi, -1
    s_add_u32 m0, s47, 0
    s_lshl_b32 s53, s58, 18
    buffer_load_dwordx4 v12, s[12:15], s53 offen lds
    buffer_load_dwordx4 v13, s[12:15], s53 offen offset:1024 lds
    s_add_u32 s58, s58, 1
    s_cmp_eq_u32 s58, 14
    s_cselect_b32 s58, 0, s58
    s_add_u32 m0, s52, 6144
    s_lshl_b32 s53, s58, 6
    s_mov_b32 exec_hi, 0xffff
    buffer_load_dwordx4 v14, s[8:11], s53 offen lds
    s_mov_b32 exec_hi, -1
    s_add_u32 m0, s47, 16384
    s_lshl_b32 s53, s58, 18
    buffer_load_dwordx4 v12, s[12:15], s53 offen lds
    buffer_load_dwordx4 v13, s[12:15], s53 offen offset:1024 lds
    s_add_u32 s58, s58, 1
    s_cmp_eq_u32 s58, 14
    s_cselect_b32 s58, 0, s58
    s_add_u32 m0, s52, 12288
    s_lshl_b32 s53, s58, 6
    s_mov_b32 exec_hi, 0xffff
    buffer_load_dwordx4 v14, s[8:11], s53 offen lds
    s_mov_b32 exec_hi, -1
    s_add_u32 m0, s47, 32768
    s_lshl_b32 s53, s58, 18
    buffer_load_dwordx4 v12, s[12:15], s53 offen lds
    buffer_load_dwordx4 v13, s[12:15], s53 offen offset:1024 lds
    s_add_u32 s58, s58, 1
    s_cmp_eq_u32 s58, 14
    s_cselect_b32 s58, 0, s58
L_first2:
    s_add_u32 s20, s36, s46
    s_addc_u32 s21, s37, 0
    s_mov_b32 s22, 262144
    s_mov_b32 s23, 0x20000
    s_mul_i32 s3, s7, 229376
    s_add_u32 s24, s40, s3
    s_addc_u32 s25, s41, 0
    s_mov_b32 s26, 229376
    s_mov_b32 s27, 0x20000
    s_lshl_b32 s54, s5, 3
    s_add_u32 s54, s54, s6
    s_mul_i32 s3, s54, 1376256
    s_add_u32 s28, s42, s3
    s_addc_u32 s29, s43, 0
    s_mov_b32 s30, 1376256
    s_mov_b32 s31, 0x20000
    s_lshl_b32 s3, s54, 12
    s_add_u32 s3, s3, 25165824
    s_add_u32 s32, s42, s3
    s_addc_u32 s33, s43, 0
    s_cmp_lg_u32 s4, 7
    s_cbranch_scc1 L_noclear
    s_lshl_b32 s3, s7, 2
    v_lshlrev_b32 v189, 8, v2
    v_add_u32 v189, s3, v189
    v_mov_b32 v190, 0
    s_mov_b64 exec, 1
    global_atomic_swap v188, v189, v190, s[32:33] sc0
    s_mov_b64 exec, -1
L_noclear:
    v_lshrrev_b32 v43, 2, v2
    v_and_b32 v43, 3, v43
    v_and_b32 v44, 3, v2
    v_and_b32 v45, 15, v2
    v_and_b32 v46, 1, v5
    v_lshl_or_b32 v46, v46, 2, v43
    v_lshlrev_b32 v46, 5, v46
    v_lshlrev_b32 v47, 3, v44
    v_lshl_add_u32 v47, v1, 6, v47
    v_xor_b32 v46, v46, v47
    v_lshl_add_u32 v46, v43, 9, v46
    v_lshl_add_u32 v15, v5, 12, v46
    v_xor_b32 v16, 32, v15
    v_add_u32 v30, 98304, v15
    v_xor_b32 v38, 32, v30
    v_lshrrev_b32 v46, 1, v43
    v_and_b32 v46, 1, v46
    v_xor_b32 v17, v43, v46
    v_and_b32 v17, 1, v17
    v_lshl_or_b32 v17, v17, 1, v46
    v_xor_b32 v17, v17, v5
    v_lshlrev_b32 v17, 4, v17
    v_lshl_add_u32 v17, v45, 6, v17
    v_add_u32 v17, 65536, v17
    v_lshlrev_b32 v18, 4, v2
    v_add_u32 v19, 0x10000, v18
    v_lshrrev_b32 v20, 1, v45
    v_xor_b32 v20, v20, v5
    v_lshlrev_b32 v20, 4, v20
    v_lshl_add_u32 v20, v45, 7, v20
    v_lshl_add_u32 v20, v1, 12, v20
    v_add_u32 v20, 65536, v20
    v_xor_b32 v21, 64, v20
    v_add_u32 v22, 65536, v20
    v_add_u32 v23, 65536, v21
    s_mul_i32 s3, s4, 6144
    v_add_u32 v39, s3, v18
    v_and_b32 v24, 1, v5
    v_lshlrev_b32 v24, 3, v24
    v_lshl_add_u32 v24, v45, 4, v24
    v_lshl_add_u32 v24, v3, 8, v24
    v_add_u32 v24, s3, v24
    v_and_b32 v25, 1, v5
    v_lshl_or_b32 v25, v25, 1, v3
    v_lshl_add_u32 v25, v25, 4, v45
    v_lshlrev_b32 v25, 5, v25
    v_add_u32 v25, 49152, v25
    v_lshl_add_u32 v26, v3, 4, v45
    v_lshlrev_b32 v26, 5, v26
    v_add_u32 v26, 51200, v26
    v_lshl_add_u32 v27, v1, 2, v25
    v_lshl_add_u32 v37, v1, 2, v26
    v_lshlrev_b32 v31, 1, v5
    v_xor_b32 v31, v31, v7
    v_lshlrev_b32 v31, 4, v31
    v_mul_u32_u24 v32, 896, v6
    v_add_u32 v31, v31, v32
    v_lshl_add_u32 v31, v1, 7, v31
    s_cmp_eq_u32 s4, 7
    s_cselect_b32 s3, 0x1000000, 0
    v_add_u32 v31, s3, v31
    v_add_u32 v32, 6144, v31
    v_lshrrev_b32 v33, 1, v43
    v_and_b32 v34, 1, v5
    v_lshl_or_b32 v33, v34, 1, v33
    v_lshlrev_b32 v33, 5, v33
    v_lshl_or_b32 v33, v44, 3, v33
    v_lshl_add_u32 v33, v43, 7, v33
    v_lshl_add_u32 v33, v5, 9, v33
    v_lshl_add_u32 v33, v1, 12, v33
    v_xor_b32 v34, 32, v33
    v_xor_b32 v35, 64, v33
    v_xor_b32 v36, 96, v33
    s_mul_i32 s3, s7, 5376
    v_lshlrev_b32 v40, 4, v0
    v_add_u32 v40, s3, v40
    v_lshrrev_b32 v42, 10, v40
    v_mul_u32_u24 v43, 43, v42
    v_lshrrev_b32 v43, 9, v43
    v_mul_u32_u24 v46, 12, v43
    v_sub_u32 v42, v42, v46
    v_and_b32 v46, 1, v42
    v_lshlrev_b32 v41, 7, v43
    v_lshl_add_u32 v41, v46, 6, v41
    v_bfe_u32 v47, v40, 8, 2
    v_lshl_add_u32 v41, v47, 3, v41
    v_lshrrev_b32 v42, 1, v42
    v_lshlrev_b32 v42, 4, v42
    v_bfe_u32 v47, v40, 4, 4
    v_add_u32 v42, v42, v47
    s_mul_i32 s3, s6, 96
    v_add_u32 v42, s3, v42
    v_mul_u32_u24 v42, 1792, v42
    v_add_u32 v41, v41, v42
    s_mul_i32 s3, s5, 896
    v_add_u32 v41, s3, v41
    v_add_u32 v42, s45, v18
    s_mov_b32 s56, 0x3db8aa3b
    s_mov_b32 s57, 0xbdb8aa3b
    s_bitcmp1_b32 s2, 5
    s_cbranch_scc1 L_cls2
    s_waitcnt vmcnt(6)
    s_barrier
    ds_read_b64_tr_b16 v[96:97], v15 offset:0
    ds_read_b64_tr_b16 v[98:99], v15 offset:2048
    ds_read_b64_tr_b16 v[100:101], v16 offset:0
    ds_read_b64_tr_b16 v[102:103], v16 offset:2048
    ds_read_b128 v[104:107], v17 offset:0
    ds_read_b128 v[108:111], v17 offset:1024
    ds_read_b128 v[112:115], v17 offset:2048
    ds_read_b128 v[116:119], v17 offset:3072
    ds_read_b128 v[120:123], v17 offset:4096
    ds_read_b128 v[124:127], v17 offset:5120
    s_add_u32 m0, s52, 18432
    s_lshl_b32 s53, s58, 6
    s_mov_b32 exec_hi, 0xffff
    buffer_load_dwordx4 v14, s[8:11], s53 offen lds
    s_mov_b32 exec_hi, -1
    s_add_u32 m0, s47, 49152
    s_lshl_b32 s53, s58, 18
    buffer_load_dwordx4 v12, s[12:15], s53 offen lds
    buffer_load_dwordx4 v13, s[12:15], s53 offen offset:1024 lds
    s_add_u32 s58, s58, 1
    s_cmp_eq_u32 s58, 14
    s_cselect_b32 s58, 0, s58
    s_waitcnt lgkmcnt(0)
    s_waitcnt vmcnt(6)
    s_barrier
    v_mfma_f32_16x16x32_bf16 v[48:51], v[96:99], v[104:107], 0
    ds_read_b64_tr_b16 v[128:129], v15 offset:16384
    ds_read_b64_tr_b16 v[130:131], v15 offset:18432
    v_mfma_f32_16x16x32_bf16 v[52:55], v[100:103], v[104:107], 0
    ds_read_b64_tr_b16 v[132:133], v16 offset:16384
    ds_read_b64_tr_b16 v[134:135], v16 offset:18432
    v_mfma_f32_16x16x32_bf16 v[56:59], v[96:99], v[108:111], 0
    ds_read_b128 v[136:139], v17 offset:6144
    v_mfma_f32_16x16x32_bf16 v[60:63], v[100:103], v[108:111], 0
    ds_read_b128 v[140:143], v17 offset:7168
    ds_read_b128 v[144:147], v17 offset:8192
    v_mfma_f32_16x16x32_bf16 v[64:67], v[96:99], v[112:115], 0
    ds_read_b128 v[148:151], v17 offset:9216
    ds_read_b128 v[152:155], v17 offset:10240
    v_mfma_f32_16x16x32_bf16 v[68:71], v[100:103], v[112:115], 0
    ds_read_b128 v[156:159], v17 offset:11264
    v_mfma_f32_16x16x32_bf16 v[72:75], v[96:99], v[116:119], 0
    s_add_u32 m0, s52, 0
    s_lshl_b32 s53, s58, 6
    s_mov_b32 exec_hi, 0xffff
    buffer_load_dwordx4 v14, s[8:11], s53 offen lds
    s_mov_b32 exec_hi, -1
    v_mfma_f32_16x16x32_bf16 v[76:79], v[100:103], v[116:119], 0
    s_add_u32 m0, s47, 0
    s_lshl_b32 s53, s58, 18
    buffer_load_dwordx4 v12, s[12:15], s53 offen lds
    v_mfma_f32_16x16x32_bf16 v[80:83], v[96:99], v[120:123], 0
    buffer_load_dwordx4 v13, s[12:15], s53 offen offset:1024 lds
    s_add_u32 s58, s58, 1
    s_cmp_eq_u32 s58, 14
    s_cselect_b32 s58, 0, s58
    v_mfma_f32_16x16x32_bf16 v[84:87], v[100:103], v[120:123], 0
    v_mfma_f32_16x16x32_bf16 v[88:91], v[96:99], v[124:127], 0
    v_mfma_f32_16x16x32_bf16 v[92:95], v[100:103], v[124:127], 0
    s_waitcnt lgkmcnt(0)
    s_waitcnt vmcnt(6)
    s_barrier
    v_mfma_f32_16x16x32_bf16 v[48:51], v[128:131], v[136:139], v[48:51]
    ds_read_b64_tr_b16 v[96:97], v15 offset:32768
    ds_read_b64_tr_b16 v[98:99], v15 offset:34816
    v_mfma_f32_16x16x32_bf16 v[52:55], v[132:135], v[136:139], v[52:55]
    ds_read_b64_tr_b16 v[100:101], v16 offset:32768
    ds_read_b64_tr_b16 v[102:103], v16 offset:34816
    v_mfma_f32_16x16x32_bf16 v[56:59], v[128:131], v[140:143], v[56:59]
    ds_read_b128 v[104:107], v17 offset:12288
    v_mfma_f32_16x16x32_bf16 v[60:63], v[132:135], v[140:143], v[60:63]
    ds_read_b128 v[108:111], v17 offset:13312
    ds_read_b128 v[112:115], v17 offset:14336
    v_mfma_f32_16x16x32_bf16 v[64:67], v[128:131], v[144:147], v[64:67]
    ds_read_b128 v[116:119], v17 offset:15360
    ds_read_b128 v[120:123], v17 offset:16384
    v_mfma_f32_16x16x32_bf16 v[68:71], v[132:135], v[144:147], v[68:71]
    ds_read_b128 v[124:127], v17 offset:17408
    v_mfma_f32_16x16x32_bf16 v[72:75], v[128:131], v[148:151], v[72:75]
    s_add_u32 m0, s52, 6144
    s_lshl_b32 s53, s58, 6
    s_mov_b32 exec_hi, 0xffff
    buffer_load_dwordx4 v14, s[8:11], s53 offen lds
    s_mov_b32 exec_hi, -1
    v_mfma_f32_16x16x32_bf16 v[76:79], v[132:135], v[148:151], v[76:79]
    s_add_u32 m0, s47, 16384
    s_lshl_b32 s53, s58, 18
    buffer_load_dwordx4 v12, s[12:15], s53 offen lds
    v_mfma_f32_16x16x32_bf16 v[80:83], v[128:131], v[152:155], v[80:83]
    buffer_load_dwordx4 v13, s[12:15], s53 offen offset:1024 lds
    s_add_u32 s58, s58, 1
    s_cmp_eq_u32 s58, 14
    s_cselect_b32 s58, 0, s58
    v_mfma_f32_16x16x32_bf16 v[84:87], v[132:135], v[152:155], v[84:87]
    v_mfma_f32_16x16x32_bf16 v[88:91], v[128:131], v[156:159], v[88:91]
    v_mfma_f32_16x16x32_bf16 v[92:95], v[132:135], v[156:159], v[92:95]
    s_waitcnt lgkmcnt(0)
    s_waitcnt vmcnt(6)
    s_barrier
    v_mfma_f32_16x16x32_bf16 v[48:51], v[96:99], v[104:107], v[48:51]
    ds_read_b64_tr_b16 v[128:129], v15 offset:49152
    ds_read_b64_tr_b16 v[130:131], v15 offset:51200
    v_mfma_f32_16x16x32_bf16 v[52:55], v[100:103], v[104:107], v[52:55]
    ds_read_b64_tr_b16 v[132:133], v16 offset:49152
    ds_read_b64_tr_b16 v[134:135], v16 offset:51200
    v_mfma_f32_16x16x32_bf16 v[56:59], v[96:99], v[108:111], v[56:59]
    ds_read_b128 v[136:139], v17 offset:18432
    v_mfma_f32_16x16x32_bf16 v[60:63], v[100:103], v[108:111], v[60:63]
    ds_read_b128 v[140:143], v17 offset:19456
    ds_read_b128 v[144:147], v17 offset:20480
    v_mfma_f32_16x16x32_bf16 v[64:67], v[96:99], v[112:115], v[64:67]
    ds_read_b128 v[148:151], v17 offset:21504
    ds_read_b128 v[152:155], v17 offset:22528
    v_mfma_f32_16x16x32_bf16 v[68:71], v[100:103], v[112:115], v[68:71]
    ds_read_b128 v[156:159], v17 offset:23552
    v_mfma_f32_16x16x32_bf16 v[72:75], v[96:99], v[116:119], v[72:75]
    s_add_u32 m0, s52, 12288
    s_lshl_b32 s53, s58, 6
    s_mov_b32 exec_hi, 0xffff
    buffer_load_dwordx4 v14, s[8:11], s53 offen lds
    s_mov_b32 exec_hi, -1
    v_mfma_f32_16x16x32_bf16 v[76:79], v[100:103], v[116:119], v[76:79]
    s_add_u32 m0, s47, 32768
    s_lshl_b32 s53, s58, 18
    buffer_load_dwordx4 v12, s[12:15], s53 offen lds
    v_mfma_f32_16x16x32_bf16 v[80:83], v[96:99], v[120:123], v[80:83]
    buffer_load_dwordx4 v13, s[12:15], s53 offen offset:1024 lds
    s_add_u32 s58, s58, 1
    s_cmp_eq_u32 s58, 14
    s_cselect_b32 s58, 0, s58
    v_mfma_f32_16x16x32_bf16 v[84:87], v[100:103], v[120:123], v[84:87]
    v_mfma_f32_16x16x32_bf16 v[88:91], v[96:99], v[124:127], v[88:91]
    v_mfma_f32_16x16x32_bf16 v[92:95], v[100:103], v[124:127], v[92:95]
    s_waitcnt lgkmcnt(0)
    s_waitcnt vmcnt(6)
    s_barrier
    v_mfma_f32_16x16x32_bf16 v[48:51], v[128:131], v[136:139], v[48:51]
    ds_read_b64_tr_b16 v[96:97], v15 offset:0
    ds_read_b64_tr_b16 v[98:99], v15 offset:2048
    v_mfma_f32_16x16x32_bf16 v[52:55], v[132:135], v[136:139], v[52:55]
    ds_read_b64_tr_b16 v[100:101], v16 offset:0
    ds_read_b64_tr_b16 v[102:103], v16 offset:2048
    v_mfma_f32_16x16x32_bf16 v[56:59], v[128:131], v[140:143], v[56:59]
    ds_read_b128 v[104:107], v17 offset:0
    v_mfma_f32_16x16x32_bf16 v[60:63], v[132:135], v[140:143], v[60:63]
    ds_read_b128 v[108:111], v17 offset:1024
    ds_read_b128 v[112:115], v17 offset:2048
    v_mfma_f32_16x16x32_bf16 v[64:67], v[128:131], v[144:147], v[64:67]
    ds_read_b128 v[116:119], v17 offset:3072
    ds_read_b128 v[120:123], v17 offset:4096
    v_mfma_f32_16x16x32_bf16 v[68:71], v[132:135], v[144:147], v[68:71]
    ds_read_b128 v[124:127], v17 offset:5120
    v_mfma_f32_16x16x32_bf16 v[72:75], v[128:131], v[148:151], v[72:75]
    s_add_u32 m0, s52, 18432
    s_lshl_b32 s53, s58, 6
    s_mov_b32 exec_hi, 0xffff
    buffer_load_dwordx4 v14, s[8:11], s53 offen lds
    s_mov_b32 exec_hi, -1
    v_mfma_f32_16x16x32_bf16 v[76:79], v[132:135], v[148:151], v[76:79]
    s_add_u32 m0, s47, 49152
    s_lshl_b32 s53, s58, 18
    buffer_load_dwordx4 v12, s[12:15], s53 offen lds
    v_mfma_f32_16x16x32_bf16 v[80:83], v[128:131], v[152:155], v[80:83]
    buffer_load_dwordx4 v13, s[12:15], s53 offen offset:1024 lds
    s_add_u32 s58, s58, 1
    s_cmp_eq_u32 s58, 14
    s_cselect_b32 s58, 0, s58
    v_mfma_f32_16x16x32_bf16 v[84:87], v[132:135], v[152:155], v[84:87]
    v_mfma_f32_16x16x32_bf16 v[88:91], v[128:131], v[156:159], v[88:91]
    v_mfma_f32_16x16x32_bf16 v[92:95], v[132:135], v[156:159], v[92:95]
    s_waitcnt lgkmcnt(0)
    s_waitcnt vmcnt(6)
    s_barrier
    v_mfma_f32_16x16x32_bf16 v[48:51], v[96:99], v[104:107], v[48:51]
    ds_read_b64_tr_b16 v[128:129], v15 offset:16384
    ds_read_b64_tr_b16 v[130:131], v15 offset:18432
    v_mfma_f32_16x16x32_bf16 v[52:55], v[100:103], v[104:107], v[52:55]
    ds_read_b64_tr_b16 v[132:133], v16 offset:16384
    ds_read_b64_tr_b16 v[134:135], v16 offset:18432
    v_mfma_f32_16x16x32_bf16 v[56:59], v[96:99], v[108:111], v[56:59]
    ds_read_b128 v[136:139], v17 offset:6144
    v_mfma_f32_16x16x32_bf16 v[60:63], v[100:103], v[108:111], v[60:63]
    ds_read_b128 v[140:143], v17 offset:7168
    ds_read_b128 v[144:147], v17 offset:8192
    v_mfma_f32_16x16x32_bf16 v[64:67], v[96:99], v[112:115], v[64:67]
    ds_read_b128 v[148:151], v17 offset:9216
    ds_read_b128 v[152:155], v17 offset:10240
    v_mfma_f32_16x16x32_bf16 v[68:71], v[100:103], v[112:115], v[68:71]
    ds_read_b128 v[156:159], v17 offset:11264
    v_mfma_f32_16x16x32_bf16 v[72:75], v[96:99], v[116:119], v[72:75]
    s_add_u32 m0, s52, 0
    s_lshl_b32 s53, s58, 6
    s_mov_b32 exec_hi, 0xffff
    buffer_load_dwordx4 v14, s[8:11], s53 offen lds
    s_mov_b32 exec_hi, -1
    v_mfma_f32_16x16x32_bf16 v[76:79], v[100:103], v[116:119], v[76:79]
    s_add_u32 m0, s47, 0
    s_lshl_b32 s53, s58, 18
    buffer_load_dwordx4 v12, s[12:15], s53 offen lds
    v_mfma_f32_16x16x32_bf16 v[80:83], v[96:99], v[120:123], v[80:83]
    buffer_load_dwordx4 v13, s[12:15], s53 offen offset:1024 lds
    s_add_u32 s58, s58, 1
    s_cmp_eq_u32 s58, 14
    s_cselect_b32 s58, 0, s58
    v_mfma_f32_16x16x32_bf16 v[84:87], v[100:103], v[120:123], v[84:87]
    v_mfma_f32_16x16x32_bf16 v[88:91], v[96:99], v[124:127], v[88:91]
    v_mfma_f32_16x16x32_bf16 v[92:95], v[100:103], v[124:127], v[92:95]
    s_waitcnt lgkmcnt(0)
    s_waitcnt vmcnt(6)
    s_barrier
    v_mfma_f32_16x16x32_bf16 v[48:51], v[128:131], v[136:139], v[48:51]
    ds_read_b64_tr_b16 v[96:97], v15 offset:32768
    ds_read_b64_tr_b16 v[98:99], v15 offset:34816
    v_mfma_f32_16x16x32_bf16 v[52:55], v[132:135], v[136:139], v[52:55]
    ds_read_b64_tr_b16 v[100:101], v16 offset:32768
    ds_read_b64_tr_b16 v[102:103], v16 offset:34816
    v_mfma_f32_16x16x32_bf16 v[56:59], v[128:131], v[140:143], v[56:59]
    ds_read_b128 v[104:107], v17 offset:12288
    v_mfma_f32_16x16x32_bf16 v[60:63], v[132:135], v[140:143], v[60:63]
    ds_read_b128 v[108:111], v17 offset:13312
    ds_read_b128 v[112:115], v17 offset:14336
    v_mfma_f32_16x16x32_bf16 v[64:67], v[128:131], v[144:147], v[64:67]
    ds_read_b128 v[116:119], v17 offset:15360
    ds_read_b128 v[120:123], v17 offset:16384
    v_mfma_f32_16x16x32_bf16 v[68:71], v[132:135], v[144:147], v[68:71]
    ds_read_b128 v[124:127], v17 offset:17408
    v_mfma_f32_16x16x32_bf16 v[72:75], v[128:131], v[148:151], v[72:75]
    s_add_u32 m0, s52, 6144
    s_lshl_b32 s53, s58, 6
    s_mov_b32 exec_hi, 0xffff
    buffer_load_dwordx4 v14, s[8:11], s53 offen lds
    s_mov_b32 exec_hi, -1
    v_mfma_f32_16x16x32_bf16 v[76:79], v[132:135], v[148:151], v[76:79]
    s_add_u32 m0, s47, 16384
    s_lshl_b32 s53, s58, 18
    buffer_load_dwordx4 v12, s[12:15], s53 offen lds
    v_mfma_f32_16x16x32_bf16 v[80:83], v[128:131], v[152:155], v[80:83]
    buffer_load_dwordx4 v13, s[12:15], s53 offen offset:1024 lds
    s_add_u32 s58, s58, 1
    s_cmp_eq_u32 s58, 14
    s_cselect_b32 s58, 0, s58
    v_mfma_f32_16x16x32_bf16 v[84:87], v[132:135], v[152:155], v[84:87]
    v_mfma_f32_16x16x32_bf16 v[88:91], v[128:131], v[156:159], v[88:91]
    v_mfma_f32_16x16x32_bf16 v[92:95], v[132:135], v[156:159], v[92:95]
    s_waitcnt lgkmcnt(0)
    s_waitcnt vmcnt(6)
    s_barrier
    v_mfma_f32_16x16x32_bf16 v[48:51], v[96:99], v[104:107], v[48:51]
    ds_read_b64_tr_b16 v[128:129], v15 offset:49152
    ds_read_b64_tr_b16 v[130:131], v15 offset:51200
    v_mfma_f32_16x16x32_bf16 v[52:55], v[100:103], v[104:107], v[52:55]
    ds_read_b64_tr_b16 v[132:133], v16 offset:49152
    ds_read_b64_tr_b16 v[134:135], v16 offset:51200
    v_mfma_f32_16x16x32_bf16 v[56:59], v[96:99], v[108:111], v[56:59]
    ds_read_b128 v[136:139], v17 offset:18432
    v_mfma_f32_16x16x32_bf16 v[60:63], v[100:103], v[108:111], v[60:63]
    ds_read_b128 v[140:143], v17 offset:19456
    ds_read_b128 v[144:147], v17 offset:20480
    v_mfma_f32_16x16x32_bf16 v[64:67], v[96:99], v[112:115], v[64:67]
    ds_read_b128 v[148:151], v17 offset:21504
    ds_read_b128 v[152:155], v17 offset:22528
    v_mfma_f32_16x16x32_bf16 v[68:71], v[100:103], v[112:115], v[68:71]
    ds_read_b128 v[156:159], v17 offset:23552
    v_mfma_f32_16x16x32_bf16 v[72:75], v[96:99], v[116:119], v[72:75]
    s_add_u32 m0, s52, 12288
    s_lshl_b32 s53, s58, 6
    s_mov_b32 exec_hi, 0xffff
    buffer_load_dwordx4 v14, s[8:11], s53 offen lds
    s_mov_b32 exec_hi, -1
    v_mfma_f32_16x16x32_bf16 v[76:79], v[100:103], v[116:119], v[76:79]
    s_add_u32 m0, s47, 32768
    s_lshl_b32 s53, s58, 18
    buffer_load_dwordx4 v12, s[12:15], s53 offen lds
    v_mfma_f32_16x16x32_bf16 v[80:83], v[96:99], v[120:123], v[80:83]
    buffer_load_dwordx4 v13, s[12:15], s53 offen offset:1024 lds
    s_add_u32 s58, s58, 1
    s_cmp_eq_u32 s58, 14
    s_cselect_b32 s58, 0, s58
    v_mfma_f32_16x16x32_bf16 v[84:87], v[100:103], v[120:123], v[84:87]
    v_mfma_f32_16x16x32_bf16 v[88:91], v[96:99], v[124:127], v[88:91]
    v_mfma_f32_16x16x32_bf16 v[92:95], v[100:103], v[124:127], v[92:95]
    s_waitcnt lgkmcnt(0)
    s_waitcnt vmcnt(6)
    s_barrier
    v_mfma_f32_16x16x32_bf16 v[48:51], v[128:131], v[136:139], v[48:51]
    ds_read_b64_tr_b16 v[96:97], v15 offset:0
    ds_read_b64_tr_b16 v[98:99], v15 offset:2048
    v_mfma_f32_16x16x32_bf16 v[52:55], v[132:135], v[136:139], v[52:55]
    ds_read_b64_tr_b16 v[100:101], v16 offset:0
    ds_read_b64_tr_b16 v[102:103], v16 offset:2048
    v_mfma_f32_16x16x32_bf16 v[56:59], v[128:131], v[140:143], v[56:59]
    ds_read_b128 v[104:107], v17 offset:0
    v_mfma_f32_16x16x32_bf16 v[60:63], v[132:135], v[140:143], v[60:63]
    ds_read_b128 v[108:111], v17 offset:1024
    ds_read_b128 v[112:115], v17 offset:2048
    v_mfma_f32_16x16x32_bf16 v[64:67], v[128:131], v[144:147], v[64:67]
    ds_read_b128 v[116:119], v17 offset:3072
    ds_read_b128 v[120:123], v17 offset:4096
    v_mfma_f32_16x16x32_bf16 v[68:71], v[132:135], v[144:147], v[68:71]
    ds_read_b128 v[124:127], v17 offset:5120
    v_mfma_f32_16x16x32_bf16 v[72:75], v[128:131], v[148:151], v[72:75]
    s_add_u32 m0, s52, 18432
    s_lshl_b32 s53, s58, 6
    s_mov_b32 exec_hi, 0xffff
    buffer_load_dwordx4 v14, s[8:11], s53 offen lds
    s_mov_b32 exec_hi, -1
    v_mfma_f32_16x16x32_bf16 v[76:79], v[132:135], v[148:151], v[76:79]
    s_add_u32 m0, s47, 49152
    s_lshl_b32 s53, s58, 18
    buffer_load_dwordx4 v12, s[12:15], s53 offen lds
    v_mfma_f32_16x16x32_bf16 v[80:83], v[128:131], v[152:155], v[80:83]
    buffer_load_dwordx4 v13, s[12:15], s53 offen offset:1024 lds
    s_add_u32 s58, s58, 1
    s_cmp_eq_u32 s58, 14
    s_cselect_b32 s58, 0, s58
    v_mfma_f32_16x16x32_bf16 v[84:87], v[132:135], v[152:155], v[84:87]
    v_mfma_f32_16x16x32_bf16 v[88:91], v[128:131], v[156:159], v[88:91]
    v_mfma_f32_16x16x32_bf16 v[92:95], v[132:135], v[156:159], v[92:95]
    s_waitcnt lgkmcnt(0)
    s_waitcnt vmcnt(6)
    s_barrier
    v_mfma_f32_16x16x32_bf16 v[48:51], v[96:99], v[104:107], v[48:51]
    ds_read_b64_tr_b16 v[128:129], v15 offset:16384
    ds_read_b64_tr_b16 v[130:131], v15 offset:18432
    v_mfma_f32_16x16x32_bf16 v[52:55], v[100:103], v[104:107], v[52:55]
    ds_read_b64_tr_b16 v[132:133], v16 offset:16384
    ds_read_b64_tr_b16 v[134:135], v16 offset:18432
    v_mfma_f32_16x16x32_bf16 v[56:59], v[96:99], v[108:111], v[56:59]
    ds_read_b128 v[136:139], v17 offset:6144
    v_mfma_f32_16x16x32_bf16 v[60:63], v[100:103], v[108:111], v[60:63]
    ds_read_b128 v[140:143], v17 offset:7168
    ds_read_b128 v[144:147], v17 offset:8192
    v_mfma_f32_16x16x32_bf16 v[64:67], v[96:99], v[112:115], v[64:67]
    ds_read_b128 v[148:151], v17 offset:9216
    ds_read_b128 v[152:155], v17 offset:10240
    v_mfma_f32_16x16x32_bf16 v[68:71], v[100:103], v[112:115], v[68:71]
    ds_read_b128 v[156:159], v17 offset:11264
    v_mfma_f32_16x16x32_bf16 v[72:75], v[96:99], v[116:119], v[72:75]
    s_add_u32 m0, s52, 0
    s_lshl_b32 s53, s58, 6
    s_mov_b32 exec_hi, 0xffff
    buffer_load_dwordx4 v14, s[8:11], s53 offen lds
    s_mov_b32 exec_hi, -1
    v_mfma_f32_16x16x32_bf16 v[76:79], v[100:103], v[116:119], v[76:79]
    s_add_u32 m0, s47, 0
    s_lshl_b32 s53, s58, 18
    buffer_load_dwordx4 v12, s[12:15], s53 offen lds
    v_mfma_f32_16x16x32_bf16 v[80:83], v[96:99], v[120:123], v[80:83]
    buffer_load_dwordx4 v13, s[12:15], s53 offen offset:1024 lds
    s_add_u32 s58, s58, 1
    s_cmp_eq_u32 s58, 14
    s_cselect_b32 s58, 0, s58
    v_mfma_f32_16x16x32_bf16 v[84:87], v[100:103], v[120:123], v[84:87]
    v_mfma_f32_16x16x32_bf16 v[88:91], v[96:99], v[124:127], v[88:91]
    v_mfma_f32_16x16x32_bf16 v[92:95], v[100:103], v[124:127], v[92:95]
    s_waitcnt lgkmcnt(0)
    s_waitcnt vmcnt(6)
    s_barrier
    v_mfma_f32_16x16x32_bf16 v[48:51], v[128:131], v[136:139], v[48:51]
    ds_read_b64_tr_b16 v[96:97], v15 offset:32768
    ds_read_b64_tr_b16 v[98:99], v15 offset:34816
    v_mfma_f32_16x16x32_bf16 v[52:55], v[132:135], v[136:139], v[52:55]
    ds_read_b64_tr_b16 v[100:101], v16 offset:32768
    ds_read_b64_tr_b16 v[102:103], v16 offset:34816
    v_mfma_f32_16x16x32_bf16 v[56:59], v[128:131], v[140:143], v[56:59]
    ds_read_b128 v[104:107], v17 offset:12288
    v_mfma_f32_16x16x32_bf16 v[60:63], v[132:135], v[140:143], v[60:63]
    ds_read_b128 v[108:111], v17 offset:13312
    ds_read_b128 v[112:115], v17 offset:14336
    v_mfma_f32_16x16x32_bf16 v[64:67], v[128:131], v[144:147], v[64:67]
    ds_read_b128 v[116:119], v17 offset:15360
    ds_read_b128 v[120:123], v17 offset:16384
    v_mfma_f32_16x16x32_bf16 v[68:71], v[132:135], v[144:147], v[68:71]
    ds_read_b128 v[124:127], v17 offset:17408
    v_mfma_f32_16x16x32_bf16 v[72:75], v[128:131], v[148:151], v[72:75]
    s_add_u32 m0, s52, 6144
    s_lshl_b32 s53, s58, 6
    s_mov_b32 exec_hi, 0xffff
    buffer_load_dwordx4 v14, s[8:11], s53 offen lds
    s_mov_b32 exec_hi, -1
    v_mfma_f32_16x16x32_bf16 v[76:79], v[132:135], v[148:151], v[76:79]
    s_add_u32 m0, s47, 16384
    s_lshl_b32 s53, s58, 18
    buffer_load_dwordx4 v12, s[12:15], s53 offen lds
    v_mfma_f32_16x16x32_bf16 v[80:83], v[128:131], v[152:155], v[80:83]
    buffer_load_dwordx4 v13, s[12:15], s53 offen offset:1024 lds
    s_add_u32 s58, s58, 1
    s_cmp_eq_u32 s58, 14
    s_cselect_b32 s58, 0, s58
    v_mfma_f32_16x16x32_bf16 v[84:87], v[132:135], v[152:155], v[84:87]
    v_mfma_f32_16x16x32_bf16 v[88:91], v[128:131], v[156:159], v[88:91]
    v_mfma_f32_16x16x32_bf16 v[92:95], v[132:135], v[156:159], v[92:95]
    s_waitcnt lgkmcnt(0)
    s_waitcnt vmcnt(6)
    s_barrier
    v_mfma_f32_16x16x32_bf16 v[48:51], v[96:99], v[104:107], v[48:51]
    ds_read_b64_tr_b16 v[128:129], v15 offset:49152
    ds_read_b64_tr_b16 v[130:131], v15 offset:51200
    v_mfma_f32_16x16x32_bf16 v[52:55], v[100:103], v[104:107], v[52:55]
    ds_read_b64_tr_b16 v[132:133], v16 offset:49152
    ds_read_b64_tr_b16 v[134:135], v16 offset:51200
    v_mfma_f32_16x16x32_bf16 v[56:59], v[96:99], v[108:111], v[56:59]
    ds_read_b128 v[136:139], v17 offset:18432
    v_mfma_f32_16x16x32_bf16 v[60:63], v[100:103], v[108:111], v[60:63]
    ds_read_b128 v[140:143], v17 offset:19456
    ds_read_b128 v[144:147], v17 offset:20480
    v_mfma_f32_16x16x32_bf16 v[64:67], v[96:99], v[112:115], v[64:67]
    ds_read_b128 v[148:151], v17 offset:21504
    ds_read_b128 v[152:155], v17 offset:22528
    v_mfma_f32_16x16x32_bf16 v[68:71], v[100:103], v[112:115], v[68:71]
    ds_read_b128 v[156:159], v17 offset:23552
    v_mfma_f32_16x16x32_bf16 v[72:75], v[96:99], v[116:119], v[72:75]
    s_add_u32 m0, s45, 131072
    s_add_u32 s53, s55, 0
    buffer_load_dwordx4 v8, s[16:19], s53 offen offset:0 nt lds
    buffer_load_dwordx4 v9, s[16:19], s53 offen offset:1024 nt lds
    v_mfma_f32_16x16x32_bf16 v[76:79], v[100:103], v[116:119], v[76:79]
    v_mfma_f32_16x16x32_bf16 v[80:83], v[96:99], v[120:123], v[80:83]
    v_mfma_f32_16x16x32_bf16 v[84:87], v[100:103], v[120:123], v[84:87]
    v_mfma_f32_16x16x32_bf16 v[88:91], v[96:99], v[124:127], v[88:91]
    v_mfma_f32_16x16x32_bf16 v[92:95], v[100:103], v[124:127], v[92:95]
    s_waitcnt lgkmcnt(0)
    s_waitcnt vmcnt(5)
    s_barrier
    v_mfma_f32_16x16x32_bf16 v[48:51], v[128:131], v[136:139], v[48:51]
    ds_read_b64_tr_b16 v[96:97], v15 offset:0
    ds_read_b64_tr_b16 v[98:99], v15 offset:2048
    v_mfma_f32_16x16x32_bf16 v[52:55], v[132:135], v[136:139], v[52:55]
    ds_read_b64_tr_b16 v[100:101], v16 offset:0
    ds_read_b64_tr_b16 v[102:103], v16 offset:2048
    v_mfma_f32_16x16x32_bf16 v[56:59], v[128:131], v[140:143], v[56:59]
    ds_read_b128 v[104:107], v17 offset:0
    v_mfma_f32_16x16x32_bf16 v[60:63], v[132:135], v[140:143], v[60:63]
    ds_read_b128 v[108:111], v17 offset:1024
    ds_read_b128 v[112:115], v17 offset:2048
    v_mfma_f32_16x16x32_bf16 v[64:67], v[128:131], v[144:147], v[64:67]
    ds_read_b128 v[116:119], v17 offset:3072
    ds_read_b128 v[120:123], v17 offset:4096
    v_mfma_f32_16x16x32_bf16 v[68:71], v[132:135], v[144:147], v[68:71]
    ds_read_b128 v[124:127], v17 offset:5120
    v_mfma_f32_16x16x32_bf16 v[72:75], v[128:131], v[148:151], v[72:75]
    s_add_u32 m0, s45, 131072
    s_add_u32 s53, s55, 0
    buffer_load_dwordx4 v10, s[16:19], s53 offen offset:2048 nt lds
    buffer_load_dwordx4 v11, s[16:19], s53 offen offset:3072 nt lds
    s_add_u32 m0, s45, 98304
    s_add_u32 s53, s55, 128
    buffer_load_dwordx4 v8, s[16:19], s53 offen offset:0 nt lds
    v_mfma_f32_16x16x32_bf16 v[76:79], v[132:135], v[148:151], v[76:79]
    v_mfma_f32_16x16x32_bf16 v[80:83], v[128:131], v[152:155], v[80:83]
    v_mfma_f32_16x16x32_bf16 v[84:87], v[132:135], v[152:155], v[84:87]
    v_mfma_f32_16x16x32_bf16 v[88:91], v[128:131], v[156:159], v[88:91]
    v_mfma_f32_16x16x32_bf16 v[92:95], v[132:135], v[156:159], v[92:95]
    s_waitcnt lgkmcnt(0)
    s_waitcnt vmcnt(5)
    s_barrier
    v_mfma_f32_16x16x32_bf16 v[48:51], v[96:99], v[104:107], v[48:51]
    ds_read_b64_tr_b16 v[128:129], v15 offset:16384
    ds_read_b64_tr_b16 v[130:131], v15 offset:18432
    v_mfma_f32_16x16x32_bf16 v[52:55], v[100:103], v[104:107], v[52:55]
    ds_read_b64_tr_b16 v[132:133], v16 offset:16384
    ds_read_b64_tr_b16 v[134:135], v16 offset:18432
    v_mfma_f32_16x16x32_bf16 v[56:59], v[96:99], v[108:111], v[56:59]
    ds_read_b128 v[136:139], v17 offset:6144
    v_mfma_f32_16x16x32_bf16 v[60:63], v[100:103], v[108:111], v[60:63]
    ds_read_b128 v[140:143], v17 offset:7168
    ds_read_b128 v[144:147], v17 offset:8192
    v_mfma_f32_16x16x32_bf16 v[64:67], v[96:99], v[112:115], v[64:67]
    ds_read_b128 v[148:151], v17 offset:9216
    ds_read_b128 v[152:155], v17 offset:10240
    v_mfma_f32_16x16x32_bf16 v[68:71], v[100:103], v[112:115], v[68:71]
    ds_read_b128 v[156:159], v17 offset:11264
    v_mfma_f32_16x16x32_bf16 v[72:75], v[96:99], v[116:119], v[72:75]
    s_add_u32 m0, s45, 98304
    s_add_u32 s53, s55, 128
    buffer_load_dwordx4 v9, s[16:19], s53 offen offset:1024 nt lds
    buffer_load_dwordx4 v10, s[16:19], s53 offen offset:2048 nt lds
    buffer_load_dwordx4 v11, s[16:19], s53 offen offset:3072 nt lds
    v_mfma_f32_16x16x32_bf16 v[76:79], v[100:103], v[116:119], v[76:79]
    v_mfma_f32_16x16x32_bf16 v[80:83], v[96:99], v[120:123], v[80:83]
    v_mfma_f32_16x16x32_bf16 v[84:87], v[100:103], v[120:123], v[84:87]
    v_mfma_f32_16x16x32_bf16 v[88:91], v[96:99], v[124:127], v[88:91]
    v_mfma_f32_16x16x32_bf16 v[92:95], v[100:103], v[124:127], v[92:95]
    s_waitcnt lgkmcnt(0)
    s_barrier
    v_mfma_f32_16x16x32_bf16 v[48:51], v[128:131], v[136:139], v[48:51]
    v_mfma_f32_16x16x32_bf16 v[52:55], v[132:135], v[136:139], v[52:55]
    v_mfma_f32_16x16x32_bf16 v[56:59], v[128:131], v[140:143], v[56:59]
    v_mfma_f32_16x16x32_bf16 v[60:63], v[132:135], v[140:143], v[60:63]
    v_mfma_f32_16x16x32_bf16 v[64:67], v[128:131], v[144:147], v[64:67]
    v_mfma_f32_16x16x32_bf16 v[68:71], v[132:135], v[144:147], v[68:71]
    v_mfma_f32_16x16x32_bf16 v[72:75], v[128:131], v[148:151], v[72:75]
    v_mfma_f32_16x16x32_bf16 v[76:79], v[132:135], v[148:151], v[76:79]
    v_mfma_f32_16x16x32_bf16 v[80:83], v[128:131], v[152:155], v[80:83]
    v_mfma_f32_16x16x32_bf16 v[84:87], v[132:135], v[152:155], v[84:87]
    v_mfma_f32_16x16x32_bf16 v[88:91], v[128:131], v[156:159], v[88:91]
    v_mfma_f32_16x16x32_bf16 v[92:95], v[132:135], v[156:159], v[92:95]
    s_nop 0
    v_cvt_pk_bf16_f32 v48, v48, v49
    v_cvt_pk_bf16_f32 v49, v50, v51
    v_cvt_pk_bf16_f32 v50, v52, v53
    v_cvt_pk_bf16_f32 v51, v54, v55
    ds_write2st64_b64 v24, v[48:49], v[50:51] offset0:0 offset1:1
    v_cvt_pk_bf16_f32 v56, v56, v57
    v_cvt_pk_bf16_f32 v57, v58, v59
    v_cvt_pk_bf16_f32 v58, v60, v61
    v_cvt_pk_bf16_f32 v59, v62, v63
    ds_write2st64_b64 v24, v[56:57], v[58:59] offset0:2 offset1:3
    v_cvt_pk_bf16_f32 v64, v64, v65
    v_cvt_pk_bf16_f32 v65, v66, v67
    v_cvt_pk_bf16_f32 v66, v68, v69
    v_cvt_pk_bf16_f32 v67, v70, v71
    ds_write2st64_b64 v24, v[64:65], v[66:67] offset0:4 offset1:5
    v_cvt_pk_bf16_f32 v72, v72, v73
    v_cvt_pk_bf16_f32 v73, v74, v75
    v_cvt_pk_bf16_f32 v74, v76, v77
    v_cvt_pk_bf16_f32 v75, v78, v79
    ds_write2st64_b64 v24, v[72:73], v[74:75] offset0:6 offset1:7
    v_cvt_pk_bf16_f32 v80, v80, v81
    v_cvt_pk_bf16_f32 v81, v82, v83
    v_cvt_pk_bf16_f32 v82, v84, v85
    v_cvt_pk_bf16_f32 v83, v86, v87
    ds_write2st64_b64 v24, v[80:81], v[82:83] offset0:8 offset1:9
    v_cvt_pk_bf16_f32 v88, v88, v89
    v_cvt_pk_bf16_f32 v89, v90, v91
    v_cvt_pk_bf16_f32 v90, v92, v93
    v_cvt_pk_bf16_f32 v91, v94, v95
    ds_write2st64_b64 v24, v[88:89], v[90:91] offset0:10 offset1:11
    s_waitcnt lgkmcnt(0)
    s_barrier
    ds_read_b128 v[144:147], v18 offset:0
    ds_read_b128 v[148:151], v18 offset:1024
    ds_read_b128 v[152:155], v18 offset:2048
    ds_read_b128 v[156:159], v18 offset:3072
    ds_read_b128 v[160:163], v18 offset:4096
    ds_read_b128 v[164:167], v18 offset:5120
    ds_read_b128 v[168:171], v18 offset:6144
    ds_read_b128 v[172:175], v18 offset:7168
    ds_read_b128 v[176:179], v18 offset:8192
    ds_read_b128 v[180:183], v18 offset:9216
    ds_read_b128 v[184:187], v18 offset:10240
    ds_read_b128 v[188:191], v18 offset:11264
    s_cmp_lg_u32 s4, 7
    s_cbranch_scc1 L_nocnt1
    s_lshl_b32 s3, s54, 4
    v_mov_b32 v44, s3
    v_mov_b32 v45, 1
    s_mov_b64 exec, 1
    global_atomic_add v44, v45, s[62:63]
    s_mov_b64 exec, -1
L_nocnt1:
    s_waitcnt vmcnt(4)
    ds_read_b128 v[192:195], v22 offset:0
    ds_read_b128 v[196:199], v22 offset:2048
    ds_read_b128 v[200:203], v23 offset:0
    ds_read_b128 v[204:207], v23 offset:2048
    s_waitcnt lgkmcnt(0)
    s_add_u32 m0, s45, 131072
    s_add_u32 s53, s55, 256
    buffer_load_dwordx4 v8, s[16:19], s53 offen offset:0 nt lds
    buffer_load_dwordx4 v9, s[16:19], s53 offen offset:1024 nt lds
    buffer_load_dwordx4 v10, s[16:19], s53 offen offset:2048 nt lds
    buffer_load_dwordx4 v11, s[16:19], s53 offen offset:3072 nt lds
    s_waitcnt vmcnt(4)
    ds_read_b128 v[208:211], v20 offset:32768
    ds_read_b128 v[212:215], v20 offset:34816
    ds_read_b128 v[216:219], v21 offset:32768
    ds_read_b128 v[220:223], v21 offset:34816
    s_waitcnt lgkmcnt(0)
    v_mfma_f32_16x16x32_bf16 v[48:51], v[192:195], v[144:147], 0
    v_mfma_f32_16x16x32_bf16 v[52:55], v[196:199], v[144:147], 0
    s_add_u32 m0, s45, 98304
    s_add_u32 s53, s55, 384
    buffer_load_dwordx4 v8, s[16:19], s53 offen offset:0 nt lds
    v_mfma_f32_16x16x32_bf16 v[56:59], v[192:195], v[148:151], 0
    v_mfma_f32_16x16x32_bf16 v[60:63], v[196:199], v[148:151], 0
    s_add_u32 m0, s45, 98304
    s_add_u32 s53, s55, 384
    buffer_load_dwordx4 v9, s[16:19], s53 offen offset:1024 nt lds
    v_mfma_f32_16x16x32_bf16 v[64:67], v[192:195], v[152:155], 0
    ds_read_b128 v[144:147], v18 offset:12288
    v_mfma_f32_16x16x32_bf16 v[68:71], v[196:199], v[152:155], 0
    s_add_u32 m0, s45, 98304
    s_add_u32 s53, s55, 384
    buffer_load_dwordx4 v10, s[16:19], s53 offen offset:2048 nt lds
    v_mfma_f32_16x16x32_bf16 v[72:75], v[192:195], v[156:159], 0
    ds_read_b128 v[148:151], v18 offset:13312
    v_mfma_f32_16x16x32_bf16 v[76:79], v[196:199], v[156:159], 0
    v_mfma_f32_16x16x32_bf16 v[80:83], v[192:195], v[160:163], 0
    ds_read_b128 v[152:155], v18 offset:14336
    v_mfma_f32_16x16x32_bf16 v[84:87], v[196:199], v[160:163], 0
    s_add_u32 m0, s45, 98304
    s_add_u32 s53, s55, 384
    buffer_load_dwordx4 v11, s[16:19], s53 offen offset:3072 nt lds
    v_mfma_f32_16x16x32_bf16 v[88:91], v[192:195], v[164:167], 0
    ds_read_b128 v[156:159], v18 offset:15360
    v_mfma_f32_16x16x32_bf16 v[92:95], v[196:199], v[164:167], 0
    s_add_u32 m0, s45, 65536
    s_add_u32 s53, s55, 16384
    buffer_load_dwordx4 v8, s[16:19], s53 offen offset:0 nt lds
    v_mfma_f32_16x16x32_bf16 v[48:51], v[200:203], v[168:171], v[48:51]
    ds_read_b128 v[160:163], v18 offset:16384
    v_mfma_f32_16x16x32_bf16 v[52:55], v[204:207], v[168:171], v[52:55]
    s_add_u32 m0, s45, 65536
    s_add_u32 s53, s55, 16384
    buffer_load_dwordx4 v9, s[16:19], s53 offen offset:1024 nt lds
    v_mfma_f32_16x16x32_bf16 v[56:59], v[200:203], v[172:175], v[56:59]
    ds_read_b128 v[164:167], v18 offset:17408
    v_mfma_f32_16x16x32_bf16 v[60:63], v[204:207], v[172:175], v[60:63]
    v_mfma_f32_16x16x32_bf16 v[64:67], v[200:203], v[176:179], v[64:67]
    ds_read_b128 v[168:171], v18 offset:18432
    v_mfma_f32_16x16x32_bf16 v[68:71], v[204:207], v[176:179], v[68:71]
    s_add_u32 m0, s45, 65536
    s_add_u32 s53, s55, 16384
    buffer_load_dwordx4 v10, s[16:19], s53 offen offset:2048 nt lds
    v_mfma_f32_16x16x32_bf16 v[72:75], v[200:203], v[180:183], v[72:75]
    ds_read_b128 v[172:175], v18 offset:19456
    v_mfma_f32_16x16x32_bf16 v[76:79], v[204:207], v[180:183], v[76:79]
    s_add_u32 m0, s45, 65536
    s_add_u32 s53, s55, 16384
    buffer_load_dwordx4 v11, s[16:19], s53 offen offset:3072 nt lds
    v_mfma_f32_16x16x32_bf16 v[80:83], v[200:203], v[184:187], v[80:83]
    ds_read_b128 v[176:179], v18 offset:20480
    v_mfma_f32_16x16x32_bf16 v[84:87], v[204:207], v[184:187], v[84:87]
    v_mfma_f32_16x16x32_bf16 v[88:91], v[200:203], v[188:191], v[88:91]
    ds_read_b128 v[180:183], v18 offset:21504
    v_mfma_f32_16x16x32_bf16 v[92:95], v[204:207], v[188:191], v[92:95]
    s_nop 1
    ds_read_b128 v[184:187], v18 offset:22528
    ds_read_b128 v[188:191], v18 offset:23552
    s_waitcnt vmcnt(8)
    ds_read_b128 v[224:227], v22 offset:0
    ds_read_b128 v[228:231], v22 offset:2048
    ds_read_b128 v[232:235], v23 offset:0
    ds_read_b128 v[236:239], v23 offset:2048
    s_waitcnt lgkmcnt(0)
    v_mfma_f32_16x16x32_bf16 v[48:51], v[208:211], v[144:147], v[48:51]
    v_mfma_f32_16x16x32_bf16 v[52:55], v[212:215], v[144:147], v[52:55]
    s_add_u32 m0, s45, 131072
    s_add_u32 s53, s55, 16512
    buffer_load_dwordx4 v8, s[16:19], s53 offen offset:0 nt lds
    v_mfma_f32_16x16x32_bf16 v[56:59], v[208:211], v[148:151], v[56:59]
    v_mfma_f32_16x16x32_bf16 v[60:63], v[212:215], v[148:151], v[60:63]
    v_mfma_f32_16x16x32_bf16 v[64:67], v[208:211], v[152:155], v[64:67]
    ds_read_b128 v[144:147], v18 offset:24576
    v_mfma_f32_16x16x32_bf16 v[68:71], v[212:215], v[152:155], v[68:71]
    s_add_u32 m0, s45, 131072
    s_add_u32 s53, s55, 16512
    buffer_load_dwordx4 v9, s[16:19], s53 offen offset:1024 nt lds
    v_mfma_f32_16x16x32_bf16 v[72:75], v[208:211], v[156:159], v[72:75]
    ds_read_b128 v[148:151], v18 offset:25600
    v_mfma_f32_16x16x32_bf16 v[76:79], v[212:215], v[156:159], v[76:79]
    v_mfma_f32_16x16x32_bf16 v[80:83], v[208:211], v[160:163], v[80:83]
    ds_read_b128 v[152:155], v18 offset:26624
    v_mfma_f32_16x16x32_bf16 v[84:87], v[212:215], v[160:163], v[84:87]
    v_mfma_f32_16x16x32_bf16 v[88:91], v[208:211], v[164:167], v[88:91]
    ds_read_b128 v[156:159], v18 offset:27648
    v_mfma_f32_16x16x32_bf16 v[92:95], v[212:215], v[164:167], v[92:95]
    s_add_u32 m0, s45, 131072
    s_add_u32 s53, s55, 16512
    buffer_load_dwordx4 v10, s[16:19], s53 offen offset:2048 nt lds
    v_mfma_f32_16x16x32_bf16 v[48:51], v[216:219], v[168:171], v[48:51]
    ds_read_b128 v[160:163], v18 offset:28672
    v_mfma_f32_16x16x32_bf16 v[52:55], v[220:223], v[168:171], v[52:55]
    v_mfma_f32_16x16x32_bf16 v[56:59], v[216:219], v[172:175], v[56:59]
    ds_read_b128 v[164:167], v18 offset:29696
    v_mfma_f32_16x16x32_bf16 v[60:63], v[220:223], v[172:175], v[60:63]
    v_mfma_f32_16x16x32_bf16 v[64:67], v[216:219], v[176:179], v[64:67]
    ds_read_b128 v[168:171], v18 offset:30720
    v_mfma_f32_16x16x32_bf16 v[68:71], v[220:223], v[176:179], v[68:71]
    s_add_u32 m0, s45, 131072
    s_add_u32 s53, s55, 16512
    buffer_load_dwordx4 v11, s[16:19], s53 offen offset:3072 nt lds
    v_mfma_f32_16x16x32_bf16 v[72:75], v[216:219], v[180:183], v[72:75]
    ds_read_b128 v[172:175], v18 offset:31744
    v_mfma_f32_16x16x32_bf16 v[76:79], v[220:223], v[180:183], v[76:79]
    v_mfma_f32_16x16x32_bf16 v[80:83], v[216:219], v[184:187], v[80:83]
    ds_read_b128 v[176:179], v18 offset:32768
    v_mfma_f32_16x16x32_bf16 v[84:87], v[220:223], v[184:187], v[84:87]
    v_mfma_f32_16x16x32_bf16 v[88:91], v[216:219], v[188:191], v[88:91]
    ds_read_b128 v[180:183], v18 offset:33792
    v_mfma_f32_16x16x32_bf16 v[92:95], v[220:223], v[188:191], v[92:95]
    s_nop 1
    ds_read_b128 v[184:187], v18 offset:34816
    ds_read_b128 v[188:191], v18 offset:35840
    s_waitcnt vmcnt(8)
    ds_read_b128 v[240:243], v20 offset:32768
    ds_read_b128 v[244:247], v20 offset:34816
    ds_read_b128 v[248:251], v21 offset:32768
    ds_read_b128 v[252:255], v21 offset:34816
    s_waitcnt lgkmcnt(0)
    v_mfma_f32_16x16x32_bf16 v[48:51], v[224:227], v[144:147], v[48:51]
    v_mfma_f32_16x16x32_bf16 v[52:55], v[228:231], v[144:147], v[52:55]
    s_add_u32 m0, s45, 98304
    s_add_u32 s53, s55, 16640
    buffer_load_dwordx4 v8, s[16:19], s53 offen offset:0 nt lds
    v_mfma_f32_16x16x32_bf16 v[56:59], v[224:227], v[148:151], v[56:59]
    v_mfma_f32_16x16x32_bf16 v[60:63], v[228:231], v[148:151], v[60:63]
    v_mfma_f32_16x16x32_bf16 v[64:67], v[224:227], v[152:155], v[64:67]
    ds_read_b128 v[144:147], v18 offset:36864
    v_mfma_f32_16x16x32_bf16 v[68:71], v[228:231], v[152:155], v[68:71]
    s_add_u32 m0, s45, 98304
    s_add_u32 s53, s55, 16640
    buffer_load_dwordx4 v9, s[16:19], s53 offen offset:1024 nt lds
    v_mfma_f32_16x16x32_bf16 v[72:75], v[224:227], v[156:159], v[72:75]
    ds_read_b128 v[148:151], v18 offset:37888
    v_mfma_f32_16x16x32_bf16 v[76:79], v[228:231], v[156:159], v[76:79]
    v_mfma_f32_16x16x32_bf16 v[80:83], v[224:227], v[160:163], v[80:83]
    ds_read_b128 v[152:155], v18 offset:38912
    v_mfma_f32_16x16x32_bf16 v[84:87], v[228:231], v[160:163], v[84:87]
    v_mfma_f32_16x16x32_bf16 v[88:91], v[224:227], v[164:167], v[88:91]
    ds_read_b128 v[156:159], v18 offset:39936
    v_mfma_f32_16x16x32_bf16 v[92:95], v[228:231], v[164:167], v[92:95]
    s_add_u32 m0, s45, 98304
    s_add_u32 s53, s55, 16640
    buffer_load_dwordx4 v10, s[16:19], s53 offen offset:2048 nt lds
    v_mfma_f32_16x16x32_bf16 v[48:51], v[232:235], v[168:171], v[48:51]
    ds_read_b128 v[160:163], v18 offset:40960
    v_mfma_f32_16x16x32_bf16 v[52:55], v[236:239], v[168:171], v[52:55]
    v_mfma_f32_16x16x32_bf16 v[56:59], v[232:235], v[172:175], v[56:59]
    ds_read_b128 v[164:167], v18 offset:41984
    v_mfma_f32_16x16x32_bf16 v[60:63], v[236:239], v[172:175], v[60:63]
    v_mfma_f32_16x16x32_bf16 v[64:67], v[232:235], v[176:179], v[64:67]
    ds_read_b128 v[168:171], v18 offset:43008
    v_mfma_f32_16x16x32_bf16 v[68:71], v[236:239], v[176:179], v[68:71]
    s_add_u32 m0, s45, 98304
    s_add_u32 s53, s55, 16640
    buffer_load_dwordx4 v11, s[16:19], s53 offen offset:3072 nt lds
    v_mfma_f32_16x16x32_bf16 v[72:75], v[232:235], v[180:183], v[72:75]
    ds_read_b128 v[172:175], v18 offset:44032
    v_mfma_f32_16x16x32_bf16 v[76:79], v[236:239], v[180:183], v[76:79]
    v_mfma_f32_16x16x32_bf16 v[80:83], v[232:235], v[184:187], v[80:83]
    ds_read_b128 v[176:179], v18 offset:45056
    v_mfma_f32_16x16x32_bf16 v[84:87], v[236:239], v[184:187], v[84:87]
    v_mfma_f32_16x16x32_bf16 v[88:91], v[232:235], v[188:191], v[88:91]
    ds_read_b128 v[180:183], v18 offset:46080
    v_mfma_f32_16x16x32_bf16 v[92:95], v[236:239], v[188:191], v[92:95]
    s_nop 1
    ds_read_b128 v[184:187], v18 offset:47104
    ds_read_b128 v[188:191], v18 offset:48128
    s_waitcnt vmcnt(8)
    ds_read_b128 v[192:195], v20 offset:0
    ds_read_b128 v[196:199], v20 offset:2048
    ds_read_b128 v[200:203], v21 offset:0
    ds_read_b128 v[204:207], v21 offset:2048
    s_waitcnt lgkmcnt(0)
    v_mfma_f32_16x16x32_bf16 v[48:51], v[240:243], v[144:147], v[48:51]
    v_mfma_f32_16x16x32_bf16 v[52:55], v[244:247], v[144:147], v[52:55]
    s_add_u32 m0, s45, 65536
    s_add_u32 s53, s55, 16768
    buffer_load_dwordx4 v8, s[16:19], s53 offen offset:0 nt lds
    v_mfma_f32_16x16x32_bf16 v[56:59], v[240:243], v[148:151], v[56:59]
    v_mfma_f32_16x16x32_bf16 v[60:63], v[244:247], v[148:151], v[60:63]
    v_mfma_f32_16x16x32_bf16 v[64:67], v[240:243], v[152:155], v[64:67]
    ds_read_b128 v[144:147], v18 offset:0
    v_mfma_f32_16x16x32_bf16 v[68:71], v[244:247], v[152:155], v[68:71]
    s_add_u32 m0, s45, 65536
    s_add_u32 s53, s55, 16768
    buffer_load_dwordx4 v9, s[16:19], s53 offen offset:1024 nt lds
    v_mfma_f32_16x16x32_bf16 v[72:75], v[240:243], v[156:159], v[72:75]
    ds_read_b128 v[148:151], v18 offset:1024
    v_mfma_f32_16x16x32_bf16 v[76:79], v[244:247], v[156:159], v[76:79]
    v_mfma_f32_16x16x32_bf16 v[80:83], v[240:243], v[160:163], v[80:83]
    ds_read_b128 v[152:155], v18 offset:2048
    v_mfma_f32_16x16x32_bf16 v[84:87], v[244:247], v[160:163], v[84:87]
    v_mfma_f32_16x16x32_bf16 v[88:91], v[240:243], v[164:167], v[88:91]
    ds_read_b128 v[156:159], v18 offset:3072
    v_mfma_f32_16x16x32_bf16 v[92:95], v[244:247], v[164:167], v[92:95]
    s_add_u32 m0, s45, 65536
    s_add_u32 s53, s55, 16768
    buffer_load_dwordx4 v10, s[16:19], s53 offen offset:2048 nt lds
    v_mfma_f32_16x16x32_bf16 v[48:51], v[248:251], v[168:171], v[48:51]
    ds_read_b128 v[160:163], v18 offset:4096
    v_mfma_f32_16x16x32_bf16 v[52:55], v[252:255], v[168:171], v[52:55]
    v_mfma_f32_16x16x32_bf16 v[56:59], v[248:251], v[172:175], v[56:59]
    ds_read_b128 v[164:167], v18 offset:5120
    v_mfma_f32_16x16x32_bf16 v[60:63], v[252:255], v[172:175], v[60:63]
    v_mfma_f32_16x16x32_bf16 v[64:67], v[248:251], v[176:179], v[64:67]
    ds_read_b128 v[168:171], v18 offset:6144
    v_mfma_f32_16x16x32_bf16 v[68:71], v[252:255], v[176:179], v[68:71]
    s_add_u32 m0, s45, 65536
    s_add_u32 s53, s55, 16768
    buffer_load_dwordx4 v11, s[16:19], s53 offen offset:3072 nt lds
    v_mfma_f32_16x16x32_bf16 v[72:75], v[248:251], v[180:183], v[72:75]
    ds_read_b128 v[172:175], v18 offset:7168
    v_mfma_f32_16x16x32_bf16 v[76:79], v[252:255], v[180:183], v[76:79]
    v_mfma_f32_16x16x32_bf16 v[80:83], v[248:251], v[184:187], v[80:83]
    ds_read_b128 v[176:179], v18 offset:8192
    v_mfma_f32_16x16x32_bf16 v[84:87], v[252:255], v[184:187], v[84:87]
    v_mfma_f32_16x16x32_bf16 v[88:91], v[248:251], v[188:191], v[88:91]
    ds_read_b128 v[180:183], v18 offset:9216
    v_mfma_f32_16x16x32_bf16 v[92:95], v[252:255], v[188:191], v[92:95]
    s_nop 1
    ds_read_b128 v[184:187], v18 offset:10240
    ds_read_b128 v[188:191], v18 offset:11264
    s_waitcnt lgkmcnt(9)
    v_mfma_f32_16x16x32_bf16 v[96:99], v[192:195], v[144:147], 0
    v_mfma_f32_16x16x32_bf16 v[100:103], v[196:199], v[144:147], 0
    v_mfma_f32_16x16x32_bf16 v[104:107], v[192:195], v[148:151], 0
    v_mfma_f32_16x16x32_bf16 v[108:111], v[196:199], v[148:151], 0
    v_mfma_f32_16x16x32_bf16 v[112:115], v[192:195], v[152:155], 0
    ds_read_b128 v[144:147], v18 offset:12288
    v_max3_f32 v12, v48, v49, v50
    v_max3_f32 v12, v12, v51, v52
    v_mfma_f32_16x16x32_bf16 v[116:119], v[196:199], v[152:155], 0
    v_max3_f32 v12, v12, v53, v54
    v_max_f32 v12, v12, v55
    s_waitcnt lgkmcnt(7)
    v_mfma_f32_16x16x32_bf16 v[120:123], v[192:195], v[156:159], 0
    ds_read_b128 v[148:151], v18 offset:13312
    v_mul_f32 v43, s57, v12
    v_fma_f32 v48, v48, s56, v43
    v_mfma_f32_16x16x32_bf16 v[124:127], v[196:199], v[156:159], 0
    v_fma_f32 v49, v49, s56, v43
    v_fma_f32 v50, v50, s56, v43
    v_mfma_f32_16x16x32_bf16 v[128:131], v[192:195], v[160:163], 0
    ds_read_b128 v[152:155], v18 offset:14336
    v_exp_f32 v48, v48
    v_fma_f32 v51, v51, s56, v43
    v_mfma_f32_16x16x32_bf16 v[132:135], v[196:199], v[160:163], 0
    v_exp_f32 v49, v49
    v_mfma_f32_16x16x32_bf16 v[136:139], v[192:195], v[164:167], 0
    ds_read_b128 v[156:159], v18 offset:15360
    v_fma_f32 v52, v52, s56, v43
    v_exp_f32 v50, v50
    v_mfma_f32_16x16x32_bf16 v[140:143], v[196:199], v[164:167], 0
    v_fma_f32 v53, v53, s56, v43
    v_exp_f32 v51, v51
    s_waitcnt lgkmcnt(7)
    v_mfma_f32_16x16x32_bf16 v[96:99], v[200:203], v[168:171], v[96:99]
    ds_read_b128 v[160:163], v18 offset:16384
    v_add_f32 v1, v48, v49
    v_fma_f32 v54, v54, s56, v43
    v_mfma_f32_16x16x32_bf16 v[100:103], v[204:207], v[168:171], v[100:103]
    v_exp_f32 v52, v52
    v_add_f32 v1, v1, v50
    v_mfma_f32_16x16x32_bf16 v[104:107], v[200:203], v[172:175], v[104:107]
    ds_read_b128 v[164:167], v18 offset:17408
    v_fma_f32 v55, v55, s56, v43
    v_exp_f32 v53, v53
    v_mfma_f32_16x16x32_bf16 v[108:111], v[204:207], v[172:175], v[108:111]
    v_add_f32 v1, v1, v51
    v_mfma_f32_16x16x32_bf16 v[112:115], v[200:203], v[176:179], v[112:115]
    ds_read_b128 v[168:171], v18 offset:18432
    v_exp_f32 v54, v54
    v_add_f32 v1, v1, v52
    v_mfma_f32_16x16x32_bf16 v[116:119], v[204:207], v[176:179], v[116:119]
    v_exp_f32 v55, v55
    v_add_f32 v1, v1, v53
    s_waitcnt lgkmcnt(7)
    v_mfma_f32_16x16x32_bf16 v[120:123], v[200:203], v[180:183], v[120:123]
    ds_read_b128 v[172:175], v18 offset:19456
    v_add_f32 v1, v1, v54
    v_add_f32 v1, v1, v55
    v_mfma_f32_16x16x32_bf16 v[124:127], v[204:207], v[180:183], v[124:127]
    v_max3_f32 v13, v56, v57, v58
    v_max3_f32 v13, v13, v59, v60
    v_mfma_f32_16x16x32_bf16 v[128:131], v[200:203], v[184:187], v[128:131]
    ds_read_b128 v[176:179], v18 offset:20480
    v_max3_f32 v13, v13, v61, v62
    v_max_f32 v13, v13, v63
    v_mfma_f32_16x16x32_bf16 v[132:135], v[204:207], v[184:187], v[132:135]
    v_mul_f32 v43, s57, v13
    v_mfma_f32_16x16x32_bf16 v[136:139], v[200:203], v[188:191], v[136:139]
    ds_read_b128 v[180:183], v18 offset:21504
    v_fma_f32 v56, v56, s56, v43
    v_fma_f32 v57, v57, s56, v43
    v_mfma_f32_16x16x32_bf16 v[140:143], v[204:207], v[188:191], v[140:143]
    v_fma_f32 v58, v58, s56, v43
    v_exp_f32 v56, v56
    s_nop 1
    ds_read_b128 v[184:187], v18 offset:22528
    ds_read_b128 v[188:191], v18 offset:23552
    s_waitcnt vmcnt(8)
    ds_read_b128 v[208:211], v22 offset:0
    ds_read_b128 v[212:215], v22 offset:2048
    ds_read_b128 v[216:219], v23 offset:0
    ds_read_b128 v[220:223], v23 offset:2048
    s_waitcnt lgkmcnt(0)
    v_mfma_f32_16x16x32_bf16 v[96:99], v[208:211], v[144:147], v[96:99]
    v_fma_f32 v59, v59, s56, v43
    v_exp_f32 v57, v57
    v_mfma_f32_16x16x32_bf16 v[100:103], v[212:215], v[144:147], v[100:103]
    s_add_u32 m0, s45, 131072
    s_mov_b32 s53, 0
    buffer_load_dwordx4 v28, s[20:23], s53 offen offset:0 nt lds
    v_fma_f32 v60, v60, s56, v43
    v_exp_f32 v58, v58
    v_mfma_f32_16x16x32_bf16 v[104:107], v[208:211], v[148:151], v[104:107]
    v_fma_f32 v61, v61, s56, v43
    v_mfma_f32_16x16x32_bf16 v[108:111], v[212:215], v[148:151], v[108:111]
    v_exp_f32 v59, v59
    v_add_f32 v3, v56, v57
    v_mfma_f32_16x16x32_bf16 v[112:115], v[208:211], v[152:155], v[112:115]
    ds_read_b128 v[144:147], v18 offset:24576
    v_fma_f32 v62, v62, s56, v43
    v_exp_f32 v60, v60
    v_mfma_f32_16x16x32_bf16 v[116:119], v[212:215], v[152:155], v[116:119]
    s_add_u32 m0, s45, 131072
    s_mov_b32 s53, 0
    buffer_load_dwordx4 v29, s[20:23], s53 offen offset:1024 nt lds
    v_add_f32 v3, v3, v58
    v_fma_f32 v63, v63, s56, v43
    v_mfma_f32_16x16x32_bf16 v[120:123], v[208:211], v[156:159], v[120:123]
    ds_read_b128 v[148:151], v18 offset:25600
    v_exp_f32 v61, v61
    v_add_f32 v3, v3, v59
    v_mfma_f32_16x16x32_bf16 v[124:127], v[212:215], v[156:159], v[124:127]
    v_exp_f32 v62, v62
    v_add_f32 v3, v3, v60
    v_mfma_f32_16x16x32_bf16 v[128:131], v[208:211], v[160:163], v[128:131]
    ds_read_b128 v[152:155], v18 offset:26624
    v_exp_f32 v63, v63
    v_mfma_f32_16x16x32_bf16 v[132:135], v[212:215], v[160:163], v[132:135]
    v_add_f32 v3, v3, v61
    v_add_f32 v3, v3, v62
    v_mfma_f32_16x16x32_bf16 v[136:139], v[208:211], v[164:167], v[136:139]
    ds_read_b128 v[156:159], v18 offset:27648
    v_add_f32 v3, v3, v63
    v_max3_f32 v14, v64, v65, v66
    v_mfma_f32_16x16x32_bf16 v[140:143], v[212:215], v[164:167], v[140:143]
    s_add_u32 m0, s45, 133120
    s_mov_b32 s53, 32768
    buffer_load_dwordx4 v28, s[20:23], s53 offen offset:0 nt lds
    v_max3_f32 v14, v14, v67, v68
    v_max3_f32 v14, v14, v69, v70
    v_mfma_f32_16x16x32_bf16 v[96:99], v[216:219], v[168:171], v[96:99]
    ds_read_b128 v[160:163], v18 offset:28672
    v_max_f32 v14, v14, v71
    v_mul_f32 v43, s57, v14
    v_mfma_f32_16x16x32_bf16 v[100:103], v[220:223], v[168:171], v[100:103]
    v_fma_f32 v64, v64, s56, v43
    v_fma_f32 v65, v65, s56, v43
    v_mfma_f32_16x16x32_bf16 v[104:107], v[216:219], v[172:175], v[104:107]
    ds_read_b128 v[164:167], v18 offset:29696
    v_fma_f32 v66, v66, s56, v43
    v_mfma_f32_16x16x32_bf16 v[108:111], v[220:223], v[172:175], v[108:111]
    v_exp_f32 v64, v64
    v_fma_f32 v67, v67, s56, v43
    v_mfma_f32_16x16x32_bf16 v[112:115], v[216:219], v[176:179], v[112:115]
    ds_read_b128 v[168:171], v18 offset:30720
    v_exp_f32 v65, v65
    v_fma_f32 v68, v68, s56, v43
    v_mfma_f32_16x16x32_bf16 v[116:119], v[220:223], v[176:179], v[116:119]
    s_add_u32 m0, s45, 133120
    s_mov_b32 s53, 32768
    buffer_load_dwordx4 v29, s[20:23], s53 offen offset:1024 nt lds
    v_exp_f32 v66, v66
    v_fma_f32 v69, v69, s56, v43
    v_mfma_f32_16x16x32_bf16 v[120:123], v[216:219], v[180:183], v[120:123]
    ds_read_b128 v[172:175], v18 offset:31744
    v_exp_f32 v67, v67
    v_add_f32 v4, v64, v65
    v_mfma_f32_16x16x32_bf16 v[124:127], v[220:223], v[180:183], v[124:127]
    v_fma_f32 v70, v70, s56, v43
    v_exp_f32 v68, v68
    v_mfma_f32_16x16x32_bf16 v[128:131], v[216:219], v[184:187], v[128:131]
    ds_read_b128 v[176:179], v18 offset:32768
    v_add_f32 v4, v4, v66
    v_mfma_f32_16x16x32_bf16 v[132:135], v[220:223], v[184:187], v[132:135]
    v_fma_f32 v71, v71, s56, v43
    v_exp_f32 v69, v69
    v_mfma_f32_16x16x32_bf16 v[136:139], v[216:219], v[188:191], v[136:139]
    ds_read_b128 v[180:183], v18 offset:33792
    v_add_f32 v4, v4, v67
    v_exp_f32 v70, v70
    v_mfma_f32_16x16x32_bf16 v[140:143], v[220:223], v[188:191], v[140:143]
    v_add_f32 v4, v4, v68
    v_exp_f32 v71, v71
    s_nop 1
    ds_read_b128 v[184:187], v18 offset:34816
    ds_read_b128 v[188:191], v18 offset:35840
    s_waitcnt vmcnt(8)
    ds_read_b128 v[224:227], v20 offset:32768
    ds_read_b128 v[228:231], v20 offset:34816
    ds_read_b128 v[232:235], v21 offset:32768
    ds_read_b128 v[236:239], v21 offset:34816
    s_waitcnt lgkmcnt(0)
    v_mfma_f32_16x16x32_bf16 v[96:99], v[224:227], v[144:147], v[96:99]
    v_add_f32 v4, v4, v69
    v_add_f32 v4, v4, v70
    v_mfma_f32_16x16x32_bf16 v[100:103], v[228:231], v[144:147], v[100:103]
    s_add_u32 m0, s45, 98304
    s_mov_b32 s53, 65536
    buffer_load_dwordx4 v28, s[20:23], s53 offen offset:0 nt lds
    v_add_f32 v4, v4, v71
    v_mfma_f32_16x16x32_bf16 v[104:107], v[224:227], v[148:151], v[104:107]
    v_max3_f32 v15, v72, v73, v74
    v_max3_f32 v15, v15, v75, v76
    v_mfma_f32_16x16x32_bf16 v[108:111], v[228:231], v[148:151], v[108:111]
    v_max3_f32 v15, v15, v77, v78
    v_max_f32 v15, v15, v79
    v_mfma_f32_16x16x32_bf16 v[112:115], v[224:227], v[152:155], v[112:115]
    ds_read_b128 v[144:147], v18 offset:36864
    v_mul_f32 v43, s57, v15
    v_fma_f32 v72, v72, s56, v43
    v_mfma_f32_16x16x32_bf16 v[116:119], v[228:231], v[152:155], v[116:119]
    s_add_u32 m0, s45, 98304
    s_mov_b32 s53, 65536
    buffer_load_dwordx4 v29, s[20:23], s53 offen offset:1024 nt lds
    v_fma_f32 v73, v73, s56, v43
    v_fma_f32 v74, v74, s56, v43
    v_mfma_f32_16x16x32_bf16 v[120:123], v[224:227], v[156:159], v[120:123]
    ds_read_b128 v[148:151], v18 offset:37888
    v_exp_f32 v72, v72
    v_fma_f32 v75, v75, s56, v43
    v_mfma_f32_16x16x32_bf16 v[124:127], v[228:231], v[156:159], v[124:127]
    v_exp_f32 v73, v73
    v_mfma_f32_16x16x32_bf16 v[128:131], v[224:227], v[160:163], v[128:131]
    ds_read_b128 v[152:155], v18 offset:38912
    v_fma_f32 v76, v76, s56, v43
    v_exp_f32 v74, v74
    v_mfma_f32_16x16x32_bf16 v[132:135], v[228:231], v[160:163], v[132:135]
    v_fma_f32 v77, v77, s56, v43
    v_exp_f32 v75, v75
    v_mfma_f32_16x16x32_bf16 v[136:139], v[224:227], v[164:167], v[136:139]
    ds_read_b128 v[156:159], v18 offset:39936
    v_add_f32 v5, v72, v73
    v_fma_f32 v78, v78, s56, v43
    v_mfma_f32_16x16x32_bf16 v[140:143], v[228:231], v[164:167], v[140:143]
    s_add_u32 m0, s45, 100352
    s_mov_b32 s53, 98304
    buffer_load_dwordx4 v28, s[20:23], s53 offen offset:0 nt lds
    v_exp_f32 v76, v76
    v_add_f32 v5, v5, v74
    v_mfma_f32_16x16x32_bf16 v[96:99], v[232:235], v[168:171], v[96:99]
    ds_read_b128 v[160:163], v18 offset:40960
    v_fma_f32 v79, v79, s56, v43
    v_exp_f32 v77, v77
    v_mfma_f32_16x16x32_bf16 v[100:103], v[236:239], v[168:171], v[100:103]
    v_add_f32 v5, v5, v75
    v_mfma_f32_16x16x32_bf16 v[104:107], v[232:235], v[172:175], v[104:107]
    ds_read_b128 v[164:167], v18 offset:41984
    v_exp_f32 v78, v78
    v_add_f32 v5, v5, v76
    v_mfma_f32_16x16x32_bf16 v[108:111], v[236:239], v[172:175], v[108:111]
    v_exp_f32 v79, v79
    v_add_f32 v5, v5, v77
    v_mfma_f32_16x16x32_bf16 v[112:115], v[232:235], v[176:179], v[112:115]
    ds_read_b128 v[168:171], v18 offset:43008
    v_add_f32 v5, v5, v78
    v_add_f32 v5, v5, v79
    v_mfma_f32_16x16x32_bf16 v[116:119], v[236:239], v[176:179], v[116:119]
    s_add_u32 m0, s45, 100352
    s_mov_b32 s53, 98304
    buffer_load_dwordx4 v29, s[20:23], s53 offen offset:1024 nt lds
    v_max3_f32 v16, v80, v81, v82
    v_max3_f32 v16, v16, v83, v84
    v_mfma_f32_16x16x32_bf16 v[120:123], v[232:235], v[180:183], v[120:123]
    ds_read_b128 v[172:175], v18 offset:44032
    v_max3_f32 v16, v16, v85, v86
    v_max_f32 v16, v16, v87
    v_mfma_f32_16x16x32_bf16 v[124:127], v[236:239], v[180:183], v[124:127]
    v_mul_f32 v43, s57, v16
    v_mfma_f32_16x16x32_bf16 v[128:131], v[232:235], v[184:187], v[128:131]
    ds_read_b128 v[176:179], v18 offset:45056
    v_fma_f32 v80, v80, s56, v43
    v_fma_f32 v81, v81, s56, v43
    v_mfma_f32_16x16x32_bf16 v[132:135], v[236:239], v[184:187], v[132:135]
    v_fma_f32 v82, v82, s56, v43
    v_exp_f32 v80, v80
    v_mfma_f32_16x16x32_bf16 v[136:139], v[232:235], v[188:191], v[136:139]
    ds_read_b128 v[180:183], v18 offset:46080
    v_fma_f32 v83, v83, s56, v43
    v_exp_f32 v81, v81
    v_mfma_f32_16x16x32_bf16 v[140:143], v[236:239], v[188:191], v[140:143]
    v_fma_f32 v84, v84, s56, v43
    v_exp_f32 v82, v82
    s_nop 1
    ds_read_b128 v[184:187], v18 offset:47104
    ds_read_b128 v[188:191], v18 offset:48128
    s_waitcnt vmcnt(8)
    ds_read_b128 v[240:243], v20 offset:0
    ds_read_b128 v[244:247], v20 offset:2048
    ds_read_b128 v[248:251], v21 offset:0
    ds_read_b128 v[252:255], v21 offset:2048
    s_waitcnt lgkmcnt(0)
    v_mfma_f32_16x16x32_bf16 v[96:99], v[240:243], v[144:147], v[96:99]
    v_fma_f32 v85, v85, s56, v43
    v_mfma_f32_16x16x32_bf16 v[100:103], v[244:247], v[144:147], v[100:103]
    s_add_u32 s53, s59, 0
    s_and_b32 s53, s53, 15
    s_mul_i32 s53, s53, 14336
    buffer_load_dwordx4 v[192:195], v31, s[24:27], s53 offen offset:0
    v_exp_f32 v83, v83
    v_add_f32 v6, v80, v81
    v_mfma_f32_16x16x32_bf16 v[104:107], v[240:243], v[148:151], v[104:107]
    v_fma_f32 v86, v86, s56, v43
    v_exp_f32 v84, v84
    v_mfma_f32_16x16x32_bf16 v[108:111], v[244:247], v[148:151], v[108:111]
    v_add_f32 v6, v6, v82
    v_fma_f32 v87, v87, s56, v43
    v_mfma_f32_16x16x32_bf16 v[112:115], v[240:243], v[152:155], v[112:115]
    v_exp_f32 v85, v85
    v_add_f32 v6, v6, v83
    v_mfma_f32_16x16x32_bf16 v[116:119], v[244:247], v[152:155], v[116:119]
    s_add_u32 s53, s59, 0
    s_and_b32 s53, s53, 15
    s_mul_i32 s53, s53, 14336
    buffer_load_dwordx4 v[196:199], v32, s[24:27], s53 offen offset:1024
    v_exp_f32 v86, v86
    v_add_f32 v6, v6, v84
    v_mfma_f32_16x16x32_bf16 v[120:123], v[240:243], v[156:159], v[120:123]
    v_exp_f32 v87, v87
    v_mfma_f32_16x16x32_bf16 v[124:127], v[244:247], v[156:159], v[124:127]
    v_add_f32 v6, v6, v85
    v_add_f32 v6, v6, v86
    v_mfma_f32_16x16x32_bf16 v[128:131], v[240:243], v[160:163], v[128:131]
    v_add_f32 v6, v6, v87
    v_max3_f32 v17, v88, v89, v90
    v_mfma_f32_16x16x32_bf16 v[132:135], v[244:247], v[160:163], v[132:135]
    v_max3_f32 v17, v17, v91, v92
    v_max3_f32 v17, v17, v93, v94
    v_mfma_f32_16x16x32_bf16 v[136:139], v[240:243], v[164:167], v[136:139]
    v_max_f32 v17, v17, v95
    v_mul_f32 v43, s57, v17
    v_mfma_f32_16x16x32_bf16 v[140:143], v[244:247], v[164:167], v[140:143]
    s_add_u32 s53, s59, 1
    s_and_b32 s53, s53, 15
    s_mul_i32 s53, s53, 14336
    buffer_load_dwordx4 v[200:203], v31, s[24:27], s53 offen offset:0
    v_fma_f32 v88, v88, s56, v43
    v_fma_f32 v89, v89, s56, v43
    v_mfma_f32_16x16x32_bf16 v[96:99], v[248:251], v[168:171], v[96:99]
    v_fma_f32 v90, v90, s56, v43
    v_mfma_f32_16x16x32_bf16 v[100:103], v[252:255], v[168:171], v[100:103]
    v_exp_f32 v88, v88
    v_fma_f32 v91, v91, s56, v43
    v_mfma_f32_16x16x32_bf16 v[104:107], v[248:251], v[172:175], v[104:107]
    v_exp_f32 v89, v89
    v_fma_f32 v92, v92, s56, v43
    v_mfma_f32_16x16x32_bf16 v[108:111], v[252:255], v[172:175], v[108:111]
    v_exp_f32 v90, v90
    v_fma_f32 v93, v93, s56, v43
    v_mfma_f32_16x16x32_bf16 v[112:115], v[248:251], v[176:179], v[112:115]
    v_exp_f32 v91, v91
    v_add_f32 v7, v88, v89
    v_mfma_f32_16x16x32_bf16 v[116:119], v[252:255], v[176:179], v[116:119]
    s_add_u32 s53, s59, 1
    s_and_b32 s53, s53, 15
    s_mul_i32 s53, s53, 14336
    buffer_load_dwordx4 v[204:207], v32, s[24:27], s53 offen offset:1024
    v_fma_f32 v94, v94, s56, v43
    v_exp_f32 v92, v92
    v_mfma_f32_16x16x32_bf16 v[120:123], v[248:251], v[180:183], v[120:123]
    v_add_f32 v7, v7, v90
    v_mfma_f32_16x16x32_bf16 v[124:127], v[252:255], v[180:183], v[124:127]
    v_fma_f32 v95, v95, s56, v43
    v_exp_f32 v93, v93
    v_mfma_f32_16x16x32_bf16 v[128:131], v[248:251], v[184:187], v[128:131]
    v_add_f32 v7, v7, v91
    v_exp_f32 v94, v94
    v_mfma_f32_16x16x32_bf16 v[132:135], v[252:255], v[184:187], v[132:135]
    v_add_f32 v7, v7, v92
    v_exp_f32 v95, v95
    v_mfma_f32_16x16x32_bf16 v[136:139], v[248:251], v[188:191], v[136:139]
    v_add_f32 v7, v7, v93
    v_add_f32 v7, v7, v94
    v_mfma_f32_16x16x32_bf16 v[140:143], v[252:255], v[188:191], v[140:143]
    v_add_f32 v7, v7, v95
    s_branch L_join
L_cls2:
    v_subrev_u32 v96, 65536, v20
    v_subrev_u32 v97, 65536, v21
    s_add_u32 m0, s45, 131072
    s_add_u32 s53, s55, 256
    buffer_load_dwordx4 v8, s[16:19], s53 offen offset:0 nt lds
    buffer_load_dwordx4 v9, s[16:19], s53 offen offset:1024 nt lds
    buffer_load_dwordx4 v10, s[16:19], s53 offen offset:2048 nt lds
    buffer_load_dwordx4 v11, s[16:19], s53 offen offset:3072 nt lds
    s_add_u32 m0, s45, 0
    s_add_u32 s53, s55, 384
    buffer_load_dwordx4 v8, s[16:19], s53 offen offset:0 nt lds
    buffer_load_dwordx4 v9, s[16:19], s53 offen offset:1024 nt lds
    buffer_load_dwordx4 v10, s[16:19], s53 offen offset:2048 nt lds
    buffer_load_dwordx4 v11, s[16:19], s53 offen offset:3072 nt lds
    s_add_u32 m0, s45, 32768
    s_add_u32 s53, s55, 16384
    buffer_load_dwordx4 v8, s[16:19], s53 offen offset:0 nt lds
    buffer_load_dwordx4 v9, s[16:19], s53 offen offset:1024 nt lds
    buffer_load_dwordx4 v10, s[16:19], s53 offen offset:2048 nt lds
    buffer_load_dwordx4 v11, s[16:19], s53 offen offset:3072 nt lds
    s_add_u32 m0, s45, 65536
    s_add_u32 s53, s55, 16512
    buffer_load_dwordx4 v8, s[16:19], s53 offen offset:0 nt lds
    buffer_load_dwordx4 v9, s[16:19], s53 offen offset:1024 nt lds
    buffer_load_dwordx4 v10, s[16:19], s53 offen offset:2048 nt lds
    buffer_load_dwordx4 v11, s[16:19], s53 offen offset:3072 nt lds
    s_add_u32 m0, s45, 98304
    s_add_u32 s53, s55, 0
    buffer_load_dwordx4 v8, s[16:19], s53 offen offset:0 nt lds
    buffer_load_dwordx4 v9, s[16:19], s53 offen offset:1024 nt lds
    buffer_load_dwordx4 v10, s[16:19], s53 offen offset:2048 nt lds
    buffer_load_dwordx4 v11, s[16:19], s53 offen offset:3072 nt lds
    s_waitcnt vmcnt(16)
    ds_read_b128 v[192:195], v22 offset:0
    ds_read_b128 v[196:199], v22 offset:2048
    ds_read_b128 v[200:203], v23 offset:0
    ds_read_b128 v[204:207], v23 offset:2048
    s_waitcnt lgkmcnt(0)
    s_add_u32 m0, s45, 131072
    s_add_u32 s53, s55, 128
    buffer_load_dwordx4 v8, s[16:19], s53 offen offset:0 nt lds
    buffer_load_dwordx4 v9, s[16:19], s53 offen offset:1024 nt lds
    buffer_load_dwordx4 v10, s[16:19], s53 offen offset:2048 nt lds
    buffer_load_dwordx4 v11, s[16:19], s53 offen offset:3072 nt lds
    s_waitcnt vmcnt(16)
    ds_read_b128 v[208:211], v96 offset:0
    ds_read_b128 v[212:215], v96 offset:2048
    ds_read_b128 v[216:219], v97 offset:0
    ds_read_b128 v[220:223], v97 offset:2048
    s_waitcnt lgkmcnt(0)
    s_waitcnt vmcnt(12)
    ds_read_b128 v[224:227], v96 offset:32768
    ds_read_b128 v[228:231], v96 offset:34816
    ds_read_b128 v[232:235], v97 offset:32768
    ds_read_b128 v[236:239], v97 offset:34816
    s_waitcnt lgkmcnt(0)
    s_waitcnt vmcnt(8)
    ds_read_b128 v[240:243], v20 offset:0
    ds_read_b128 v[244:247], v20 offset:2048
    ds_read_b128 v[248:251], v21 offset:0
    ds_read_b128 v[252:255], v21 offset:2048
    s_waitcnt lgkmcnt(0)
    s_barrier
    s_add_u32 m0, s52, 0
    s_lshl_b32 s53, s58, 6
    s_mov_b32 exec_hi, 0xffff
    buffer_load_dwordx4 v14, s[8:11], s53 offen lds
    s_mov_b32 exec_hi, -1
    s_add_u32 m0, s47, 0
    s_lshl_b32 s53, s58, 18
    buffer_load_dwordx4 v12, s[12:15], s53 offen lds
    buffer_load_dwordx4 v13, s[12:15], s53 offen offset:1024 lds
    s_add_u32 s58, s58, 1
    s_cmp_eq_u32 s58, 14
    s_cselect_b32 s58, 0, s58
    s_add_u32 m0, s52, 6144
    s_lshl_b32 s53, s58, 6
    s_mov_b32 exec_hi, 0xffff
    buffer_load_dwordx4 v14, s[8:11], s53 offen lds
    s_mov_b32 exec_hi, -1
    s_add_u32 m0, s47, 16384
    s_lshl_b32 s53, s58, 18
    buffer_load_dwordx4 v12, s[12:15], s53 offen lds
    buffer_load_dwordx4 v13, s[12:15], s53 offen offset:1024 lds
    s_add_u32 s58, s58, 1
    s_cmp_eq_u32 s58, 14
    s_cselect_b32 s58, 0, s58
    s_add_u32 m0, s52, 12288
    s_lshl_b32 s53, s58, 6
    s_mov_b32 exec_hi, 0xffff
    buffer_load_dwordx4 v14, s[8:11], s53 offen lds
    s_mov_b32 exec_hi, -1
    s_add_u32 m0, s47, 32768
    s_lshl_b32 s53, s58, 18
    buffer_load_dwordx4 v12, s[12:15], s53 offen lds
    buffer_load_dwordx4 v13, s[12:15], s53 offen offset:1024 lds
    s_add_u32 s58, s58, 1
    s_cmp_eq_u32 s58, 14
    s_cselect_b32 s58, 0, s58
    s_waitcnt vmcnt(6)
    s_barrier
    ds_read_b64_tr_b16 v[96:97], v15 offset:0
    ds_read_b64_tr_b16 v[98:99], v15 offset:2048
    ds_read_b64_tr_b16 v[100:101], v16 offset:0
    ds_read_b64_tr_b16 v[102:103], v16 offset:2048
    ds_read_b128 v[104:107], v17 offset:0
    ds_read_b128 v[108:111], v17 offset:1024
    ds_read_b128 v[112:115], v17 offset:2048
    ds_read_b128 v[116:119], v17 offset:3072
    ds_read_b128 v[120:123], v17 offset:4096
    ds_read_b128 v[124:127], v17 offset:5120
    s_add_u32 m0, s52, 18432
    s_lshl_b32 s53, s58, 6
    s_mov_b32 exec_hi, 0xffff
    buffer_load_dwordx4 v14, s[8:11], s53 offen lds
    s_mov_b32 exec_hi, -1
    s_add_u32 m0, s47, 49152
    s_lshl_b32 s53, s58, 18
    buffer_load_dwordx4 v12, s[12:15], s53 offen lds
    buffer_load_dwordx4 v13, s[12:15], s53 offen offset:1024 lds
    s_add_u32 s58, s58, 1
    s_cmp_eq_u32 s58, 14
    s_cselect_b32 s58, 0, s58
    s_waitcnt lgkmcnt(0)
    s_waitcnt vmcnt(6)
    s_barrier
    v_mfma_f32_16x16x32_bf16 v[48:51], v[96:99], v[104:107], 0
    ds_read_b64_tr_b16 v[128:129], v15 offset:16384
    ds_read_b64_tr_b16 v[130:131], v15 offset:18432
    v_mfma_f32_16x16x32_bf16 v[52:55], v[100:103], v[104:107], 0
    ds_read_b64_tr_b16 v[132:133], v16 offset:16384
    ds_read_b64_tr_b16 v[134:135], v16 offset:18432
    v_mfma_f32_16x16x32_bf16 v[56:59], v[96:99], v[108:111], 0
    ds_read_b128 v[136:139], v17 offset:6144
    v_mfma_f32_16x16x32_bf16 v[60:63], v[100:103], v[108:111], 0
    ds_read_b128 v[140:143], v17 offset:7168
    ds_read_b128 v[144:147], v17 offset:8192
    v_mfma_f32_16x16x32_bf16 v[64:67], v[96:99], v[112:115], 0
    ds_read_b128 v[148:151], v17 offset:9216
    ds_read_b128 v[152:155], v17 offset:10240
    v_mfma_f32_16x16x32_bf16 v[68:71], v[100:103], v[112:115], 0
    ds_read_b128 v[156:159], v17 offset:11264
    v_mfma_f32_16x16x32_bf16 v[72:75], v[96:99], v[116:119], 0
    s_add_u32 m0, s52, 0
    s_lshl_b32 s53, s58, 6
    s_mov_b32 exec_hi, 0xffff
    buffer_load_dwordx4 v14, s[8:11], s53 offen lds
    s_mov_b32 exec_hi, -1
    v_mfma_f32_16x16x32_bf16 v[76:79], v[100:103], v[116:119], 0
    s_add_u32 m0, s47, 0
    s_lshl_b32 s53, s58, 18
    buffer_load_dwordx4 v12, s[12:15], s53 offen lds
    v_mfma_f32_16x16x32_bf16 v[80:83], v[96:99], v[120:123], 0
    buffer_load_dwordx4 v13, s[12:15], s53 offen offset:1024 lds
    s_add_u32 s58, s58, 1
    s_cmp_eq_u32 s58, 14
    s_cselect_b32 s58, 0, s58
    v_mfma_f32_16x16x32_bf16 v[84:87], v[100:103], v[120:123], 0
    v_mfma_f32_16x16x32_bf16 v[88:91], v[96:99], v[124:127], 0
    v_mfma_f32_16x16x32_bf16 v[92:95], v[100:103], v[124:127], 0
    s_waitcnt lgkmcnt(0)
    s_waitcnt vmcnt(6)
    s_barrier
    v_mfma_f32_16x16x32_bf16 v[48:51], v[128:131], v[136:139], v[48:51]
    ds_read_b64_tr_b16 v[96:97], v15 offset:32768
    ds_read_b64_tr_b16 v[98:99], v15 offset:34816
    v_mfma_f32_16x16x32_bf16 v[52:55], v[132:135], v[136:139], v[52:55]
    ds_read_b64_tr_b16 v[100:101], v16 offset:32768
    ds_read_b64_tr_b16 v[102:103], v16 offset:34816
    v_mfma_f32_16x16x32_bf16 v[56:59], v[128:131], v[140:143], v[56:59]
    ds_read_b128 v[104:107], v17 offset:12288
    v_mfma_f32_16x16x32_bf16 v[60:63], v[132:135], v[140:143], v[60:63]
    ds_read_b128 v[108:111], v17 offset:13312
    ds_read_b128 v[112:115], v17 offset:14336
    v_mfma_f32_16x16x32_bf16 v[64:67], v[128:131], v[144:147], v[64:67]
    ds_read_b128 v[116:119], v17 offset:15360
    ds_read_b128 v[120:123], v17 offset:16384
    v_mfma_f32_16x16x32_bf16 v[68:71], v[132:135], v[144:147], v[68:71]
    ds_read_b128 v[124:127], v17 offset:17408
    v_mfma_f32_16x16x32_bf16 v[72:75], v[128:131], v[148:151], v[72:75]
    s_add_u32 m0, s52, 6144
    s_lshl_b32 s53, s58, 6
    s_mov_b32 exec_hi, 0xffff
    buffer_load_dwordx4 v14, s[8:11], s53 offen lds
    s_mov_b32 exec_hi, -1
    v_mfma_f32_16x16x32_bf16 v[76:79], v[132:135], v[148:151], v[76:79]
    s_add_u32 m0, s47, 16384
    s_lshl_b32 s53, s58, 18
    buffer_load_dwordx4 v12, s[12:15], s53 offen lds
    v_mfma_f32_16x16x32_bf16 v[80:83], v[128:131], v[152:155], v[80:83]
    buffer_load_dwordx4 v13, s[12:15], s53 offen offset:1024 lds
    s_add_u32 s58, s58, 1
    s_cmp_eq_u32 s58, 14
    s_cselect_b32 s58, 0, s58
    v_mfma_f32_16x16x32_bf16 v[84:87], v[132:135], v[152:155], v[84:87]
    v_mfma_f32_16x16x32_bf16 v[88:91], v[128:131], v[156:159], v[88:91]
    v_mfma_f32_16x16x32_bf16 v[92:95], v[132:135], v[156:159], v[92:95]
    s_waitcnt lgkmcnt(0)
    s_waitcnt vmcnt(6)
    s_barrier
    v_mfma_f32_16x16x32_bf16 v[48:51], v[96:99], v[104:107], v[48:51]
    ds_read_b64_tr_b16 v[128:129], v15 offset:49152
    ds_read_b64_tr_b16 v[130:131], v15 offset:51200
    v_mfma_f32_16x16x32_bf16 v[52:55], v[100:103], v[104:107], v[52:55]
    ds_read_b64_tr_b16 v[132:133], v16 offset:49152
    ds_read_b64_tr_b16 v[134:135], v16 offset:51200
    v_mfma_f32_16x16x32_bf16 v[56:59], v[96:99], v[108:111], v[56:59]
    ds_read_b128 v[136:139], v17 offset:18432
    v_mfma_f32_16x16x32_bf16 v[60:63], v[100:103], v[108:111], v[60:63]
    ds_read_b128 v[140:143], v17 offset:19456
    ds_read_b128 v[144:147], v17 offset:20480
    v_mfma_f32_16x16x32_bf16 v[64:67], v[96:99], v[112:115], v[64:67]
    ds_read_b128 v[148:151], v17 offset:21504
    ds_read_b128 v[152:155], v17 offset:22528
    v_mfma_f32_16x16x32_bf16 v[68:71], v[100:103], v[112:115], v[68:71]
    ds_read_b128 v[156:159], v17 offset:23552
    v_mfma_f32_16x16x32_bf16 v[72:75], v[96:99], v[116:119], v[72:75]
    s_add_u32 m0, s52, 12288
    s_lshl_b32 s53, s58, 6
    s_mov_b32 exec_hi, 0xffff
    buffer_load_dwordx4 v14, s[8:11], s53 offen lds
    s_mov_b32 exec_hi, -1
    v_mfma_f32_16x16x32_bf16 v[76:79], v[100:103], v[116:119], v[76:79]
    s_add_u32 m0, s47, 32768
    s_lshl_b32 s53, s58, 18
    buffer_load_dwordx4 v12, s[12:15], s53 offen lds
    v_mfma_f32_16x16x32_bf16 v[80:83], v[96:99], v[120:123], v[80:83]
    buffer_load_dwordx4 v13, s[12:15], s53 offen offset:1024 lds
    s_add_u32 s58, s58, 1
    s_cmp_eq_u32 s58, 14
    s_cselect_b32 s58, 0, s58
    v_mfma_f32_16x16x32_bf16 v[84:87], v[100:103], v[120:123], v[84:87]
    v_mfma_f32_16x16x32_bf16 v[88:91], v[96:99], v[124:127], v[88:91]
    v_mfma_f32_16x16x32_bf16 v[92:95], v[100:103], v[124:127], v[92:95]
    s_waitcnt lgkmcnt(0)
    s_waitcnt vmcnt(6)
    s_barrier
    v_mfma_f32_16x16x32_bf16 v[48:51], v[128:131], v[136:139], v[48:51]
    ds_read_b64_tr_b16 v[96:97], v15 offset:0
    ds_read_b64_tr_b16 v[98:99], v15 offset:2048
    v_mfma_f32_16x16x32_bf16 v[52:55], v[132:135], v[136:139], v[52:55]
    ds_read_b64_tr_b16 v[100:101], v16 offset:0
    ds_read_b64_tr_b16 v[102:103], v16 offset:2048
    v_mfma_f32_16x16x32_bf16 v[56:59], v[128:131], v[140:143], v[56:59]
    ds_read_b128 v[104:107], v17 offset:0
    v_mfma_f32_16x16x32_bf16 v[60:63], v[132:135], v[140:143], v[60:63]
    ds_read_b128 v[108:111], v17 offset:1024
    ds_read_b128 v[112:115], v17 offset:2048
    v_mfma_f32_16x16x32_bf16 v[64:67], v[128:131], v[144:147], v[64:67]
    ds_read_b128 v[116:119], v17 offset:3072
    ds_read_b128 v[120:123], v17 offset:4096
    v_mfma_f32_16x16x32_bf16 v[68:71], v[132:135], v[144:147], v[68:71]
    ds_read_b128 v[124:127], v17 offset:5120
    v_mfma_f32_16x16x32_bf16 v[72:75], v[128:131], v[148:151], v[72:75]
    s_add_u32 m0, s52, 18432
    s_lshl_b32 s53, s58, 6
    s_mov_b32 exec_hi, 0xffff
    buffer_load_dwordx4 v14, s[8:11], s53 offen lds
    s_mov_b32 exec_hi, -1
    v_mfma_f32_16x16x32_bf16 v[76:79], v[132:135], v[148:151], v[76:79]
    s_add_u32 m0, s47, 49152
    s_lshl_b32 s53, s58, 18
    buffer_load_dwordx4 v12, s[12:15], s53 offen lds
    v_mfma_f32_16x16x32_bf16 v[80:83], v[128:131], v[152:155], v[80:83]
    buffer_load_dwordx4 v13, s[12:15], s53 offen offset:1024 lds
    s_add_u32 s58, s58, 1
    s_cmp_eq_u32 s58, 14
    s_cselect_b32 s58, 0, s58
    v_mfma_f32_16x16x32_bf16 v[84:87], v[132:135], v[152:155], v[84:87]
    v_mfma_f32_16x16x32_bf16 v[88:91], v[128:131], v[156:159], v[88:91]
    v_mfma_f32_16x16x32_bf16 v[92:95], v[132:135], v[156:159], v[92:95]
    s_waitcnt lgkmcnt(0)
    s_waitcnt vmcnt(6)
    s_barrier
    v_mfma_f32_16x16x32_bf16 v[48:51], v[96:99], v[104:107], v[48:51]
    ds_read_b64_tr_b16 v[128:129], v15 offset:16384
    ds_read_b64_tr_b16 v[130:131], v15 offset:18432
    v_mfma_f32_16x16x32_bf16 v[52:55], v[100:103], v[104:107], v[52:55]
    ds_read_b64_tr_b16 v[132:133], v16 offset:16384
    ds_read_b64_tr_b16 v[134:135], v16 offset:18432
    v_mfma_f32_16x16x32_bf16 v[56:59], v[96:99], v[108:111], v[56:59]
    ds_read_b128 v[136:139], v17 offset:6144
    v_mfma_f32_16x16x32_bf16 v[60:63], v[100:103], v[108:111], v[60:63]
    ds_read_b128 v[140:143], v17 offset:7168
    ds_read_b128 v[144:147], v17 offset:8192
    v_mfma_f32_16x16x32_bf16 v[64:67], v[96:99], v[112:115], v[64:67]
    ds_read_b128 v[148:151], v17 offset:9216
    ds_read_b128 v[152:155], v17 offset:10240
    v_mfma_f32_16x16x32_bf16 v[68:71], v[100:103], v[112:115], v[68:71]
    ds_read_b128 v[156:159], v17 offset:11264
    v_mfma_f32_16x16x32_bf16 v[72:75], v[96:99], v[116:119], v[72:75]
    s_add_u32 m0, s52, 0
    s_lshl_b32 s53, s58, 6
    s_mov_b32 exec_hi, 0xffff
    buffer_load_dwordx4 v14, s[8:11], s53 offen lds
    s_mov_b32 exec_hi, -1
    v_mfma_f32_16x16x32_bf16 v[76:79], v[100:103], v[116:119], v[76:79]
    s_add_u32 m0, s47, 0
    s_lshl_b32 s53, s58, 18
    buffer_load_dwordx4 v12, s[12:15], s53 offen lds
    v_mfma_f32_16x16x32_bf16 v[80:83], v[96:99], v[120:123], v[80:83]
    buffer_load_dwordx4 v13, s[12:15], s53 offen offset:1024 lds
    s_add_u32 s58, s58, 1
    s_cmp_eq_u32 s58, 14
    s_cselect_b32 s58, 0, s58
    v_mfma_f32_16x16x32_bf16 v[84:87], v[100:103], v[120:123], v[84:87]
    v_mfma_f32_16x16x32_bf16 v[88:91], v[96:99], v[124:127], v[88:91]
    v_mfma_f32_16x16x32_bf16 v[92:95], v[100:103], v[124:127], v[92:95]
    s_waitcnt lgkmcnt(0)
    s_waitcnt vmcnt(6)
    s_barrier
    v_mfma_f32_16x16x32_bf16 v[48:51], v[128:131], v[136:139], v[48:51]
    ds_read_b64_tr_b16 v[96:97], v15 offset:32768
    ds_read_b64_tr_b16 v[98:99], v15 offset:34816
    v_mfma_f32_16x16x32_bf16 v[52:55], v[132:135], v[136:139], v[52:55]
    ds_read_b64_tr_b16 v[100:101], v16 offset:32768
    ds_read_b64_tr_b16 v[102:103], v16 offset:34816
    v_mfma_f32_16x16x32_bf16 v[56:59], v[128:131], v[140:143], v[56:59]
    ds_read_b128 v[104:107], v17 offset:12288
    v_mfma_f32_16x16x32_bf16 v[60:63], v[132:135], v[140:143], v[60:63]
    ds_read_b128 v[108:111], v17 offset:13312
    ds_read_b128 v[112:115], v17 offset:14336
    v_mfma_f32_16x16x32_bf16 v[64:67], v[128:131], v[144:147], v[64:67]
    ds_read_b128 v[116:119], v17 offset:15360
    ds_read_b128 v[120:123], v17 offset:16384
    v_mfma_f32_16x16x32_bf16 v[68:71], v[132:135], v[144:147], v[68:71]
    ds_read_b128 v[124:127], v17 offset:17408
    v_mfma_f32_16x16x32_bf16 v[72:75], v[128:131], v[148:151], v[72:75]
    s_add_u32 m0, s52, 6144
    s_lshl_b32 s53, s58, 6
    s_mov_b32 exec_hi, 0xffff
    buffer_load_dwordx4 v14, s[8:11], s53 offen lds
    s_mov_b32 exec_hi, -1
    v_mfma_f32_16x16x32_bf16 v[76:79], v[132:135], v[148:151], v[76:79]
    s_add_u32 m0, s47, 16384
    s_lshl_b32 s53, s58, 18
    buffer_load_dwordx4 v12, s[12:15], s53 offen lds
    v_mfma_f32_16x16x32_bf16 v[80:83], v[128:131], v[152:155], v[80:83]
    buffer_load_dwordx4 v13, s[12:15], s53 offen offset:1024 lds
    s_add_u32 s58, s58, 1
    s_cmp_eq_u32 s58, 14
    s_cselect_b32 s58, 0, s58
    v_mfma_f32_16x16x32_bf16 v[84:87], v[132:135], v[152:155], v[84:87]
    v_mfma_f32_16x16x32_bf16 v[88:91], v[128:131], v[156:159], v[88:91]
    v_mfma_f32_16x16x32_bf16 v[92:95], v[132:135], v[156:159], v[92:95]
    s_waitcnt lgkmcnt(0)
    s_waitcnt vmcnt(6)
    s_barrier
    v_mfma_f32_16x16x32_bf16 v[48:51], v[96:99], v[104:107], v[48:51]
    ds_read_b64_tr_b16 v[128:129], v15 offset:49152
    ds_read_b64_tr_b16 v[130:131], v15 offset:51200
    v_mfma_f32_16x16x32_bf16 v[52:55], v[100:103], v[104:107], v[52:55]
    ds_read_b64_tr_b16 v[132:133], v16 offset:49152
    ds_read_b64_tr_b16 v[134:135], v16 offset:51200
    v_mfma_f32_16x16x32_bf16 v[56:59], v[96:99], v[108:111], v[56:59]
    ds_read_b128 v[136:139], v17 offset:18432
    v_mfma_f32_16x16x32_bf16 v[60:63], v[100:103], v[108:111], v[60:63]
    ds_read_b128 v[140:143], v17 offset:19456
    ds_read_b128 v[144:147], v17 offset:20480
    v_mfma_f32_16x16x32_bf16 v[64:67], v[96:99], v[112:115], v[64:67]
    ds_read_b128 v[148:151], v17 offset:21504
    ds_read_b128 v[152:155], v17 offset:22528
    v_mfma_f32_16x16x32_bf16 v[68:71], v[100:103], v[112:115], v[68:71]
    ds_read_b128 v[156:159], v17 offset:23552
    v_mfma_f32_16x16x32_bf16 v[72:75], v[96:99], v[116:119], v[72:75]
    s_add_u32 m0, s52, 12288
    s_lshl_b32 s53, s58, 6
    s_mov_b32 exec_hi, 0xffff
    buffer_load_dwordx4 v14, s[8:11], s53 offen lds
    s_mov_b32 exec_hi, -1
    v_mfma_f32_16x16x32_bf16 v[76:79], v[100:103], v[116:119], v[76:79]
    s_add_u32 m0, s47, 32768
    s_lshl_b32 s53, s58, 18
    buffer_load_dwordx4 v12, s[12:15], s53 offen lds
    v_mfma_f32_16x16x32_bf16 v[80:83], v[96:99], v[120:123], v[80:83]
    buffer_load_dwordx4 v13, s[12:15], s53 offen offset:1024 lds
    s_add_u32 s58, s58, 1
    s_cmp_eq_u32 s58, 14
    s_cselect_b32 s58, 0, s58
    v_mfma_f32_16x16x32_bf16 v[84:87], v[100:103], v[120:123], v[84:87]
    v_mfma_f32_16x16x32_bf16 v[88:91], v[96:99], v[124:127], v[88:91]
    v_mfma_f32_16x16x32_bf16 v[92:95], v[100:103], v[124:127], v[92:95]
    s_waitcnt lgkmcnt(0)
    s_waitcnt vmcnt(6)
    s_barrier
    v_mfma_f32_16x16x32_bf16 v[48:51], v[128:131], v[136:139], v[48:51]
    ds_read_b64_tr_b16 v[96:97], v15 offset:0
    ds_read_b64_tr_b16 v[98:99], v15 offset:2048
    v_mfma_f32_16x16x32_bf16 v[52:55], v[132:135], v[136:139], v[52:55]
    ds_read_b64_tr_b16 v[100:101], v16 offset:0
    ds_read_b64_tr_b16 v[102:103], v16 offset:2048
    v_mfma_f32_16x16x32_bf16 v[56:59], v[128:131], v[140:143], v[56:59]
    ds_read_b128 v[104:107], v17 offset:0
    v_mfma_f32_16x16x32_bf16 v[60:63], v[132:135], v[140:143], v[60:63]
    ds_read_b128 v[108:111], v17 offset:1024
    ds_read_b128 v[112:115], v17 offset:2048
    v_mfma_f32_16x16x32_bf16 v[64:67], v[128:131], v[144:147], v[64:67]
    ds_read_b128 v[116:119], v17 offset:3072
    ds_read_b128 v[120:123], v17 offset:4096
    v_mfma_f32_16x16x32_bf16 v[68:71], v[132:135], v[144:147], v[68:71]
    ds_read_b128 v[124:127], v17 offset:5120
    v_mfma_f32_16x16x32_bf16 v[72:75], v[128:131], v[148:151], v[72:75]
    s_add_u32 m0, s52, 18432
    s_lshl_b32 s53, s58, 6
    s_mov_b32 exec_hi, 0xffff
    buffer_load_dwordx4 v14, s[8:11], s53 offen lds
    s_mov_b32 exec_hi, -1
    v_mfma_f32_16x16x32_bf16 v[76:79], v[132:135], v[148:151], v[76:79]
    s_add_u32 m0, s47, 49152
    s_lshl_b32 s53, s58, 18
    buffer_load_dwordx4 v12, s[12:15], s53 offen lds
    v_mfma_f32_16x16x32_bf16 v[80:83], v[128:131], v[152:155], v[80:83]
    buffer_load_dwordx4 v13, s[12:15], s53 offen offset:1024 lds
    s_add_u32 s58, s58, 1
    s_cmp_eq_u32 s58, 14
    s_cselect_b32 s58, 0, s58
    v_mfma_f32_16x16x32_bf16 v[84:87], v[132:135], v[152:155], v[84:87]
    v_mfma_f32_16x16x32_bf16 v[88:91], v[128:131], v[156:159], v[88:91]
    v_mfma_f32_16x16x32_bf16 v[92:95], v[132:135], v[156:159], v[92:95]
    s_waitcnt lgkmcnt(0)
    s_waitcnt vmcnt(6)
    s_barrier
    v_mfma_f32_16x16x32_bf16 v[48:51], v[96:99], v[104:107], v[48:51]
    ds_read_b64_tr_b16 v[128:129], v15 offset:16384
    ds_read_b64_tr_b16 v[130:131], v15 offset:18432
    v_mfma_f32_16x16x32_bf16 v[52:55], v[100:103], v[104:107], v[52:55]
    ds_read_b64_tr_b16 v[132:133], v16 offset:16384
    ds_read_b64_tr_b16 v[134:135], v16 offset:18432
    v_mfma_f32_16x16x32_bf16 v[56:59], v[96:99], v[108:111], v[56:59]
    ds_read_b128 v[136:139], v17 offset:6144
    v_mfma_f32_16x16x32_bf16 v[60:63], v[100:103], v[108:111], v[60:63]
    ds_read_b128 v[140:143], v17 offset:7168
    ds_read_b128 v[144:147], v17 offset:8192
    v_mfma_f32_16x16x32_bf16 v[64:67], v[96:99], v[112:115], v[64:67]
    ds_read_b128 v[148:151], v17 offset:9216
    ds_read_b128 v[152:155], v17 offset:10240
    v_mfma_f32_16x16x32_bf16 v[68:71], v[100:103], v[112:115], v[68:71]
    ds_read_b128 v[156:159], v17 offset:11264
    v_mfma_f32_16x16x32_bf16 v[72:75], v[96:99], v[116:119], v[72:75]
    s_add_u32 m0, s52, 0
    s_lshl_b32 s53, s58, 6
    s_mov_b32 exec_hi, 0xffff
    buffer_load_dwordx4 v14, s[8:11], s53 offen lds
    s_mov_b32 exec_hi, -1
    v_mfma_f32_16x16x32_bf16 v[76:79], v[100:103], v[116:119], v[76:79]
    s_add_u32 m0, s47, 0
    s_lshl_b32 s53, s58, 18
    buffer_load_dwordx4 v12, s[12:15], s53 offen lds
    v_mfma_f32_16x16x32_bf16 v[80:83], v[96:99], v[120:123], v[80:83]
    buffer_load_dwordx4 v13, s[12:15], s53 offen offset:1024 lds
    s_add_u32 s58, s58, 1
    s_cmp_eq_u32 s58, 14
    s_cselect_b32 s58, 0, s58
    v_mfma_f32_16x16x32_bf16 v[84:87], v[100:103], v[120:123], v[84:87]
    v_mfma_f32_16x16x32_bf16 v[88:91], v[96:99], v[124:127], v[88:91]
    v_mfma_f32_16x16x32_bf16 v[92:95], v[100:103], v[124:127], v[92:95]
    s_waitcnt lgkmcnt(0)
    s_waitcnt vmcnt(6)
    s_barrier
    v_mfma_f32_16x16x32_bf16 v[48:51], v[128:131], v[136:139], v[48:51]
    ds_read_b64_tr_b16 v[96:97], v15 offset:32768
    ds_read_b64_tr_b16 v[98:99], v15 offset:34816
    v_mfma_f32_16x16x32_bf16 v[52:55], v[132:135], v[136:139], v[52:55]
    ds_read_b64_tr_b16 v[100:101], v16 offset:32768
    ds_read_b64_tr_b16 v[102:103], v16 offset:34816
    v_mfma_f32_16x16x32_bf16 v[56:59], v[128:131], v[140:143], v[56:59]
    ds_read_b128 v[104:107], v17 offset:12288
    v_mfma_f32_16x16x32_bf16 v[60:63], v[132:135], v[140:143], v[60:63]
    ds_read_b128 v[108:111], v17 offset:13312
    ds_read_b128 v[112:115], v17 offset:14336
    v_mfma_f32_16x16x32_bf16 v[64:67], v[128:131], v[144:147], v[64:67]
    ds_read_b128 v[116:119], v17 offset:15360
    ds_read_b128 v[120:123], v17 offset:16384
    v_mfma_f32_16x16x32_bf16 v[68:71], v[132:135], v[144:147], v[68:71]
    ds_read_b128 v[124:127], v17 offset:17408
    v_mfma_f32_16x16x32_bf16 v[72:75], v[128:131], v[148:151], v[72:75]
    s_add_u32 m0, s52, 6144
    s_lshl_b32 s53, s58, 6
    s_mov_b32 exec_hi, 0xffff
    buffer_load_dwordx4 v14, s[8:11], s53 offen lds
    s_mov_b32 exec_hi, -1
    v_mfma_f32_16x16x32_bf16 v[76:79], v[132:135], v[148:151], v[76:79]
    s_add_u32 m0, s47, 16384
    s_lshl_b32 s53, s58, 18
    buffer_load_dwordx4 v12, s[12:15], s53 offen lds
    v_mfma_f32_16x16x32_bf16 v[80:83], v[128:131], v[152:155], v[80:83]
    buffer_load_dwordx4 v13, s[12:15], s53 offen offset:1024 lds
    s_add_u32 s58, s58, 1
    s_cmp_eq_u32 s58, 14
    s_cselect_b32 s58, 0, s58
    v_mfma_f32_16x16x32_bf16 v[84:87], v[132:135], v[152:155], v[84:87]
    v_mfma_f32_16x16x32_bf16 v[88:91], v[128:131], v[156:159], v[88:91]
    v_mfma_f32_16x16x32_bf16 v[92:95], v[132:135], v[156:159], v[92:95]
    s_waitcnt lgkmcnt(0)
    s_waitcnt vmcnt(6)
    s_barrier
    v_mfma_f32_16x16x32_bf16 v[48:51], v[96:99], v[104:107], v[48:51]
    ds_read_b64_tr_b16 v[128:129], v15 offset:49152
    ds_read_b64_tr_b16 v[130:131], v15 offset:51200
    v_mfma_f32_16x16x32_bf16 v[52:55], v[100:103], v[104:107], v[52:55]
    ds_read_b64_tr_b16 v[132:133], v16 offset:49152
    ds_read_b64_tr_b16 v[134:135], v16 offset:51200
    v_mfma_f32_16x16x32_bf16 v[56:59], v[96:99], v[108:111], v[56:59]
    ds_read_b128 v[136:139], v17 offset:18432
    v_mfma_f32_16x16x32_bf16 v[60:63], v[100:103], v[108:111], v[60:63]
    ds_read_b128 v[140:143], v17 offset:19456
    ds_read_b128 v[144:147], v17 offset:20480
    v_mfma_f32_16x16x32_bf16 v[64:67], v[96:99], v[112:115], v[64:67]
    ds_read_b128 v[148:151], v17 offset:21504
    ds_read_b128 v[152:155], v17 offset:22528
    v_mfma_f32_16x16x32_bf16 v[68:71], v[100:103], v[112:115], v[68:71]
    ds_read_b128 v[156:159], v17 offset:23552
    v_mfma_f32_16x16x32_bf16 v[72:75], v[96:99], v[116:119], v[72:75]
    v_mfma_f32_16x16x32_bf16 v[76:79], v[100:103], v[116:119], v[76:79]
    v_mfma_f32_16x16x32_bf16 v[80:83], v[96:99], v[120:123], v[80:83]
    v_mfma_f32_16x16x32_bf16 v[84:87], v[100:103], v[120:123], v[84:87]
    v_mfma_f32_16x16x32_bf16 v[88:91], v[96:99], v[124:127], v[88:91]
    v_mfma_f32_16x16x32_bf16 v[92:95], v[100:103], v[124:127], v[92:95]
    s_waitcnt lgkmcnt(0)
    s_waitcnt vmcnt(3)
    s_barrier
    v_mfma_f32_16x16x32_bf16 v[48:51], v[128:131], v[136:139], v[48:51]
    ds_read_b64_tr_b16 v[96:97], v15 offset:0
    ds_read_b64_tr_b16 v[98:99], v15 offset:2048
    v_mfma_f32_16x16x32_bf16 v[52:55], v[132:135], v[136:139], v[52:55]
    ds_read_b64_tr_b16 v[100:101], v16 offset:0
    ds_read_b64_tr_b16 v[102:103], v16 offset:2048
    v_mfma_f32_16x16x32_bf16 v[56:59], v[128:131], v[140:143], v[56:59]
    ds_read_b128 v[104:107], v17 offset:0
    v_mfma_f32_16x16x32_bf16 v[60:63], v[132:135], v[140:143], v[60:63]
    ds_read_b128 v[108:111], v17 offset:1024
    ds_read_b128 v[112:115], v17 offset:2048
    v_mfma_f32_16x16x32_bf16 v[64:67], v[128:131], v[144:147], v[64:67]
    ds_read_b128 v[116:119], v17 offset:3072
    ds_read_b128 v[120:123], v17 offset:4096
    v_mfma_f32_16x16x32_bf16 v[68:71], v[132:135], v[144:147], v[68:71]
    ds_read_b128 v[124:127], v17 offset:5120
    v_mfma_f32_16x16x32_bf16 v[72:75], v[128:131], v[148:151], v[72:75]
    v_mfma_f32_16x16x32_bf16 v[76:79], v[132:135], v[148:151], v[76:79]
    v_mfma_f32_16x16x32_bf16 v[80:83], v[128:131], v[152:155], v[80:83]
    v_mfma_f32_16x16x32_bf16 v[84:87], v[132:135], v[152:155], v[84:87]
    v_mfma_f32_16x16x32_bf16 v[88:91], v[128:131], v[156:159], v[88:91]
    v_mfma_f32_16x16x32_bf16 v[92:95], v[132:135], v[156:159], v[92:95]
    s_waitcnt lgkmcnt(0)
    s_waitcnt vmcnt(0)
    s_barrier
    v_mfma_f32_16x16x32_bf16 v[48:51], v[96:99], v[104:107], v[48:51]
    ds_read_b64_tr_b16 v[128:129], v15 offset:16384
    ds_read_b64_tr_b16 v[130:131], v15 offset:18432
    v_mfma_f32_16x16x32_bf16 v[52:55], v[100:103], v[104:107], v[52:55]
    ds_read_b64_tr_b16 v[132:133], v16 offset:16384
    ds_read_b64_tr_b16 v[134:135], v16 offset:18432
    v_mfma_f32_16x16x32_bf16 v[56:59], v[96:99], v[108:111], v[56:59]
    ds_read_b128 v[136:139], v17 offset:6144
    v_mfma_f32_16x16x32_bf16 v[60:63], v[100:103], v[108:111], v[60:63]
    ds_read_b128 v[140:143], v17 offset:7168
    ds_read_b128 v[144:147], v17 offset:8192
    v_mfma_f32_16x16x32_bf16 v[64:67], v[96:99], v[112:115], v[64:67]
    ds_read_b128 v[148:151], v17 offset:9216
    ds_read_b128 v[152:155], v17 offset:10240
    v_mfma_f32_16x16x32_bf16 v[68:71], v[100:103], v[112:115], v[68:71]
    ds_read_b128 v[156:159], v17 offset:11264
    v_mfma_f32_16x16x32_bf16 v[72:75], v[96:99], v[116:119], v[72:75]
    v_mfma_f32_16x16x32_bf16 v[76:79], v[100:103], v[116:119], v[76:79]
    v_mfma_f32_16x16x32_bf16 v[80:83], v[96:99], v[120:123], v[80:83]
    v_mfma_f32_16x16x32_bf16 v[84:87], v[100:103], v[120:123], v[84:87]
    v_mfma_f32_16x16x32_bf16 v[88:91], v[96:99], v[124:127], v[88:91]
    v_mfma_f32_16x16x32_bf16 v[92:95], v[100:103], v[124:127], v[92:95]
    s_waitcnt lgkmcnt(0)
    s_barrier
    v_mfma_f32_16x16x32_bf16 v[48:51], v[128:131], v[136:139], v[48:51]
    v_mfma_f32_16x16x32_bf16 v[52:55], v[132:135], v[136:139], v[52:55]
    v_mfma_f32_16x16x32_bf16 v[56:59], v[128:131], v[140:143], v[56:59]
    v_mfma_f32_16x16x32_bf16 v[60:63], v[132:135], v[140:143], v[60:63]
    v_mfma_f32_16x16x32_bf16 v[64:67], v[128:131], v[144:147], v[64:67]
    v_mfma_f32_16x16x32_bf16 v[68:71], v[132:135], v[144:147], v[68:71]
    v_mfma_f32_16x16x32_bf16 v[72:75], v[128:131], v[148:151], v[72:75]
    v_mfma_f32_16x16x32_bf16 v[76:79], v[132:135], v[148:151], v[76:79]
    v_mfma_f32_16x16x32_bf16 v[80:83], v[128:131], v[152:155], v[80:83]
    v_mfma_f32_16x16x32_bf16 v[84:87], v[132:135], v[152:155], v[84:87]
    v_mfma_f32_16x16x32_bf16 v[88:91], v[128:131], v[156:159], v[88:91]
    v_mfma_f32_16x16x32_bf16 v[92:95], v[132:135], v[156:159], v[92:95]
    s_nop 0
    v_cvt_pk_bf16_f32 v48, v48, v49
    v_cvt_pk_bf16_f32 v49, v50, v51
    v_cvt_pk_bf16_f32 v50, v52, v53
    v_cvt_pk_bf16_f32 v51, v54, v55
    ds_write2st64_b64 v24, v[48:49], v[50:51] offset0:0 offset1:1
    v_cvt_pk_bf16_f32 v56, v56, v57
    v_cvt_pk_bf16_f32 v57, v58, v59
    v_cvt_pk_bf16_f32 v58, v60, v61
    v_cvt_pk_bf16_f32 v59, v62, v63
    ds_write2st64_b64 v24, v[56:57], v[58:59] offset0:2 offset1:3
    v_cvt_pk_bf16_f32 v64, v64, v65
    v_cvt_pk_bf16_f32 v65, v66, v67
    v_cvt_pk_bf16_f32 v66, v68, v69
    v_cvt_pk_bf16_f32 v67, v70, v71
    ds_write2st64_b64 v24, v[64:65], v[66:67] offset0:4 offset1:5
    v_cvt_pk_bf16_f32 v72, v72, v73
    v_cvt_pk_bf16_f32 v73, v74, v75
    v_cvt_pk_bf16_f32 v74, v76, v77
    v_cvt_pk_bf16_f32 v75, v78, v79
    ds_write2st64_b64 v24, v[72:73], v[74:75] offset0:6 offset1:7
    v_cvt_pk_bf16_f32 v80, v80, v81
    v_cvt_pk_bf16_f32 v81, v82, v83
    v_cvt_pk_bf16_f32 v82, v84, v85
    v_cvt_pk_bf16_f32 v83, v86, v87
    ds_write2st64_b64 v24, v[80:81], v[82:83] offset0:8 offset1:9
    v_cvt_pk_bf16_f32 v88, v88, v89
    v_cvt_pk_bf16_f32 v89, v90, v91
    v_cvt_pk_bf16_f32 v90, v92, v93
    v_cvt_pk_bf16_f32 v91, v94, v95
    ds_write2st64_b64 v24, v[88:89], v[90:91] offset0:10 offset1:11
    s_waitcnt lgkmcnt(0)
    s_barrier
    ds_read_b128 v[144:147], v18 offset:0
    ds_read_b128 v[148:151], v18 offset:1024
    ds_read_b128 v[152:155], v18 offset:2048
    ds_read_b128 v[156:159], v18 offset:3072
    ds_read_b128 v[160:163], v18 offset:4096
    ds_read_b128 v[164:167], v18 offset:5120
    ds_read_b128 v[168:171], v18 offset:6144
    ds_read_b128 v[172:175], v18 offset:7168
    ds_read_b128 v[176:179], v18 offset:8192
    ds_read_b128 v[180:183], v18 offset:9216
    ds_read_b128 v[184:187], v18 offset:10240
    ds_read_b128 v[188:191], v18 offset:11264
    s_cmp_lg_u32 s4, 7
    s_cbranch_scc1 L_nocnt2
    s_lshl_b32 s3, s54, 4
    v_mov_b32 v44, s3
    v_mov_b32 v45, 1
    s_mov_b64 exec, 1
    global_atomic_add v44, v45, s[62:63]
    s_mov_b64 exec, -1
L_nocnt2:
    ds_read_b128 v[96:99], v20 offset:32768
    ds_read_b128 v[100:103], v20 offset:34816
    ds_read_b128 v[104:107], v21 offset:32768
    ds_read_b128 v[108:111], v21 offset:34816
    ds_read_b128 v[112:115], v22 offset:0
    ds_read_b128 v[116:119], v22 offset:2048
    ds_read_b128 v[120:123], v23 offset:0
    ds_read_b128 v[124:127], v23 offset:2048
    s_waitcnt lgkmcnt(0)
    v_mfma_f32_16x16x32_bf16 v[48:51], v[96:99], v[144:147], 0
    v_mfma_f32_16x16x32_bf16 v[52:55], v[100:103], v[144:147], 0
    s_add_u32 m0, s45, 65536
    s_add_u32 s53, s55, 16640
    buffer_load_dwordx4 v8, s[16:19], s53 offen offset:0 nt lds
    v_mfma_f32_16x16x32_bf16 v[56:59], v[96:99], v[148:151], 0
    v_mfma_f32_16x16x32_bf16 v[60:63], v[100:103], v[148:151], 0
    v_mfma_f32_16x16x32_bf16 v[64:67], v[96:99], v[152:155], 0
    ds_read_b128 v[144:147], v18 offset:12288
    v_mfma_f32_16x16x32_bf16 v[68:71], v[100:103], v[152:155], 0
    s_add_u32 m0, s45, 65536
    s_add_u32 s53, s55, 16640
    buffer_load_dwordx4 v9, s[16:19], s53 offen offset:1024 nt lds
    v_mfma_f32_16x16x32_bf16 v[72:75], v[96:99], v[156:159], 0
    ds_read_b128 v[148:151], v18 offset:13312
    v_mfma_f32_16x16x32_bf16 v[76:79], v[100:103], v[156:159], 0
    v_mfma_f32_16x16x32_bf16 v[80:83], v[96:99], v[160:163], 0
    ds_read_b128 v[152:155], v18 offset:14336
    v_mfma_f32_16x16x32_bf16 v[84:87], v[100:103], v[160:163], 0
    v_mfma_f32_16x16x32_bf16 v[88:91], v[96:99], v[164:167], 0
    ds_read_b128 v[156:159], v18 offset:15360
    v_mfma_f32_16x16x32_bf16 v[92:95], v[100:103], v[164:167], 0
    s_add_u32 m0, s45, 65536
    s_add_u32 s53, s55, 16640
    buffer_load_dwordx4 v10, s[16:19], s53 offen offset:2048 nt lds
    v_mfma_f32_16x16x32_bf16 v[48:51], v[104:107], v[168:171], v[48:51]
    ds_read_b128 v[160:163], v18 offset:16384
    v_mfma_f32_16x16x32_bf16 v[52:55], v[108:111], v[168:171], v[52:55]
    v_mfma_f32_16x16x32_bf16 v[56:59], v[104:107], v[172:175], v[56:59]
    ds_read_b128 v[164:167], v18 offset:17408
    v_mfma_f32_16x16x32_bf16 v[60:63], v[108:111], v[172:175], v[60:63]
    v_mfma_f32_16x16x32_bf16 v[64:67], v[104:107], v[176:179], v[64:67]
    ds_read_b128 v[168:171], v18 offset:18432
    v_mfma_f32_16x16x32_bf16 v[68:71], v[108:111], v[176:179], v[68:71]
    s_add_u32 m0, s45, 65536
    s_add_u32 s53, s55, 16640
    buffer_load_dwordx4 v11, s[16:19], s53 offen offset:3072 nt lds
    v_mfma_f32_16x16x32_bf16 v[72:75], v[104:107], v[180:183], v[72:75]
    ds_read_b128 v[172:175], v18 offset:19456
    v_mfma_f32_16x16x32_bf16 v[76:79], v[108:111], v[180:183], v[76:79]
    v_mfma_f32_16x16x32_bf16 v[80:83], v[104:107], v[184:187], v[80:83]
    ds_read_b128 v[176:179], v18 offset:20480
    v_mfma_f32_16x16x32_bf16 v[84:87], v[108:111], v[184:187], v[84:87]
    v_mfma_f32_16x16x32_bf16 v[88:91], v[104:107], v[188:191], v[88:91]
    ds_read_b128 v[180:183], v18 offset:21504
    v_mfma_f32_16x16x32_bf16 v[92:95], v[108:111], v[188:191], v[92:95]
    s_nop 1
    ds_read_b128 v[184:187], v18 offset:22528
    ds_read_b128 v[188:191], v18 offset:23552
    s_waitcnt lgkmcnt(9)
    v_mfma_f32_16x16x32_bf16 v[48:51], v[112:115], v[144:147], v[48:51]
    v_mfma_f32_16x16x32_bf16 v[52:55], v[116:119], v[144:147], v[52:55]
    s_add_u32 m0, s45, 98304
    s_add_u32 s53, s55, 16768
    buffer_load_dwordx4 v8, s[16:19], s53 offen offset:0 nt lds
    v_mfma_f32_16x16x32_bf16 v[56:59], v[112:115], v[148:151], v[56:59]
    v_mfma_f32_16x16x32_bf16 v[60:63], v[116:119], v[148:151], v[60:63]
    v_mfma_f32_16x16x32_bf16 v[64:67], v[112:115], v[152:155], v[64:67]
    ds_read_b128 v[144:147], v18 offset:24576
    v_mfma_f32_16x16x32_bf16 v[68:71], v[116:119], v[152:155], v[68:71]
    s_add_u32 m0, s45, 98304
    s_add_u32 s53, s55, 16768
    buffer_load_dwordx4 v9, s[16:19], s53 offen offset:1024 nt lds
    s_waitcnt lgkmcnt(7)
    v_mfma_f32_16x16x32_bf16 v[72:75], v[112:115], v[156:159], v[72:75]
    ds_read_b128 v[148:151], v18 offset:25600
    v_mfma_f32_16x16x32_bf16 v[76:79], v[116:119], v[156:159], v[76:79]
    v_mfma_f32_16x16x32_bf16 v[80:83], v[112:115], v[160:163], v[80:83]
    ds_read_b128 v[152:155], v18 offset:26624
    v_mfma_f32_16x16x32_bf16 v[84:87], v[116:119], v[160:163], v[84:87]
    v_mfma_f32_16x16x32_bf16 v[88:91], v[112:115], v[164:167], v[88:91]
    ds_read_b128 v[156:159], v18 offset:27648
    v_mfma_f32_16x16x32_bf16 v[92:95], v[116:119], v[164:167], v[92:95]
    s_add_u32 m0, s45, 98304
    s_add_u32 s53, s55, 16768
    buffer_load_dwordx4 v10, s[16:19], s53 offen offset:2048 nt lds
    s_waitcnt lgkmcnt(7)
    v_mfma_f32_16x16x32_bf16 v[48:51], v[120:123], v[168:171], v[48:51]
    ds_read_b128 v[160:163], v18 offset:28672
    v_mfma_f32_16x16x32_bf16 v[52:55], v[124:127], v[168:171], v[52:55]
    v_mfma_f32_16x16x32_bf16 v[56:59], v[120:123], v[172:175], v[56:59]
    ds_read_b128 v[164:167], v18 offset:29696
    v_mfma_f32_16x16x32_bf16 v[60:63], v[124:127], v[172:175], v[60:63]
    v_mfma_f32_16x16x32_bf16 v[64:67], v[120:123], v[176:179], v[64:67]
    ds_read_b128 v[168:171], v18 offset:30720
    v_mfma_f32_16x16x32_bf16 v[68:71], v[124:127], v[176:179], v[68:71]
    s_add_u32 m0, s45, 98304
    s_add_u32 s53, s55, 16768
    buffer_load_dwordx4 v11, s[16:19], s53 offen offset:3072 nt lds
    s_waitcnt lgkmcnt(7)
    v_mfma_f32_16x16x32_bf16 v[72:75], v[120:123], v[180:183], v[72:75]
    ds_read_b128 v[172:175], v18 offset:31744
    v_mfma_f32_16x16x32_bf16 v[76:79], v[124:127], v[180:183], v[76:79]
    v_mfma_f32_16x16x32_bf16 v[80:83], v[120:123], v[184:187], v[80:83]
    ds_read_b128 v[176:179], v18 offset:32768
    v_mfma_f32_16x16x32_bf16 v[84:87], v[124:127], v[184:187], v[84:87]
    v_mfma_f32_16x16x32_bf16 v[88:91], v[120:123], v[188:191], v[88:91]
    ds_read_b128 v[180:183], v18 offset:33792
    v_mfma_f32_16x16x32_bf16 v[92:95], v[124:127], v[188:191], v[92:95]
    s_nop 1
    ds_read_b128 v[184:187], v18 offset:34816
    ds_read_b128 v[188:191], v18 offset:35840
    s_waitcnt lgkmcnt(9)
    v_mfma_f32_16x16x32_bf16 v[48:51], v[192:195], v[144:147], v[48:51]
    v_mfma_f32_16x16x32_bf16 v[52:55], v[196:199], v[144:147], v[52:55]
    v_mfma_f32_16x16x32_bf16 v[56:59], v[192:195], v[148:151], v[56:59]
    v_mfma_f32_16x16x32_bf16 v[60:63], v[196:199], v[148:151], v[60:63]
    v_mfma_f32_16x16x32_bf16 v[64:67], v[192:195], v[152:155], v[64:67]
    ds_read_b128 v[144:147], v18 offset:36864
    v_mfma_f32_16x16x32_bf16 v[68:71], v[196:199], v[152:155], v[68:71]
    s_waitcnt lgkmcnt(7)
    v_mfma_f32_16x16x32_bf16 v[72:75], v[192:195], v[156:159], v[72:75]
    ds_read_b128 v[148:151], v18 offset:37888
    v_mfma_f32_16x16x32_bf16 v[76:79], v[196:199], v[156:159], v[76:79]
    v_mfma_f32_16x16x32_bf16 v[80:83], v[192:195], v[160:163], v[80:83]
    ds_read_b128 v[152:155], v18 offset:38912
    v_mfma_f32_16x16x32_bf16 v[84:87], v[196:199], v[160:163], v[84:87]
    v_mfma_f32_16x16x32_bf16 v[88:91], v[192:195], v[164:167], v[88:91]
    ds_read_b128 v[156:159], v18 offset:39936
    v_mfma_f32_16x16x32_bf16 v[92:95], v[196:199], v[164:167], v[92:95]
    s_waitcnt lgkmcnt(7)
    v_mfma_f32_16x16x32_bf16 v[48:51], v[200:203], v[168:171], v[48:51]
    ds_read_b128 v[160:163], v18 offset:40960
    v_mfma_f32_16x16x32_bf16 v[52:55], v[204:207], v[168:171], v[52:55]
    v_mfma_f32_16x16x32_bf16 v[56:59], v[200:203], v[172:175], v[56:59]
    ds_read_b128 v[164:167], v18 offset:41984
    v_mfma_f32_16x16x32_bf16 v[60:63], v[204:207], v[172:175], v[60:63]
    v_mfma_f32_16x16x32_bf16 v[64:67], v[200:203], v[176:179], v[64:67]
    ds_read_b128 v[168:171], v18 offset:43008
    v_mfma_f32_16x16x32_bf16 v[68:71], v[204:207], v[176:179], v[68:71]
    s_waitcnt lgkmcnt(7)
    v_mfma_f32_16x16x32_bf16 v[72:75], v[200:203], v[180:183], v[72:75]
    ds_read_b128 v[172:175], v18 offset:44032
    v_mfma_f32_16x16x32_bf16 v[76:79], v[204:207], v[180:183], v[76:79]
    v_mfma_f32_16x16x32_bf16 v[80:83], v[200:203], v[184:187], v[80:83]
    ds_read_b128 v[176:179], v18 offset:45056
    v_mfma_f32_16x16x32_bf16 v[84:87], v[204:207], v[184:187], v[84:87]
    v_mfma_f32_16x16x32_bf16 v[88:91], v[200:203], v[188:191], v[88:91]
    ds_read_b128 v[180:183], v18 offset:46080
    v_mfma_f32_16x16x32_bf16 v[92:95], v[204:207], v[188:191], v[92:95]
    s_nop 1
    ds_read_b128 v[184:187], v18 offset:47104
    ds_read_b128 v[188:191], v18 offset:48128
    s_waitcnt lgkmcnt(9)
    v_mfma_f32_16x16x32_bf16 v[48:51], v[208:211], v[144:147], v[48:51]
    v_mfma_f32_16x16x32_bf16 v[52:55], v[212:215], v[144:147], v[52:55]
    v_mfma_f32_16x16x32_bf16 v[56:59], v[208:211], v[148:151], v[56:59]
    v_mfma_f32_16x16x32_bf16 v[60:63], v[212:215], v[148:151], v[60:63]
    v_mfma_f32_16x16x32_bf16 v[64:67], v[208:211], v[152:155], v[64:67]
    ds_read_b128 v[144:147], v18 offset:0
    v_mfma_f32_16x16x32_bf16 v[68:71], v[212:215], v[152:155], v[68:71]
    s_waitcnt lgkmcnt(7)
    v_mfma_f32_16x16x32_bf16 v[72:75], v[208:211], v[156:159], v[72:75]
    ds_read_b128 v[148:151], v18 offset:1024
    v_mfma_f32_16x16x32_bf16 v[76:79], v[212:215], v[156:159], v[76:79]
    v_mfma_f32_16x16x32_bf16 v[80:83], v[208:211], v[160:163], v[80:83]
    ds_read_b128 v[152:155], v18 offset:2048
    v_mfma_f32_16x16x32_bf16 v[84:87], v[212:215], v[160:163], v[84:87]
    v_mfma_f32_16x16x32_bf16 v[88:91], v[208:211], v[164:167], v[88:91]
    ds_read_b128 v[156:159], v18 offset:3072
    v_mfma_f32_16x16x32_bf16 v[92:95], v[212:215], v[164:167], v[92:95]
    s_waitcnt lgkmcnt(7)
    v_mfma_f32_16x16x32_bf16 v[48:51], v[216:219], v[168:171], v[48:51]
    ds_read_b128 v[160:163], v18 offset:4096
    v_mfma_f32_16x16x32_bf16 v[52:55], v[220:223], v[168:171], v[52:55]
    v_mfma_f32_16x16x32_bf16 v[56:59], v[216:219], v[172:175], v[56:59]
    ds_read_b128 v[164:167], v18 offset:5120
    v_mfma_f32_16x16x32_bf16 v[60:63], v[220:223], v[172:175], v[60:63]
    v_mfma_f32_16x16x32_bf16 v[64:67], v[216:219], v[176:179], v[64:67]
    ds_read_b128 v[168:171], v18 offset:6144
    v_mfma_f32_16x16x32_bf16 v[68:71], v[220:223], v[176:179], v[68:71]
    s_waitcnt lgkmcnt(7)
    v_mfma_f32_16x16x32_bf16 v[72:75], v[216:219], v[180:183], v[72:75]
    ds_read_b128 v[172:175], v18 offset:7168
    v_mfma_f32_16x16x32_bf16 v[76:79], v[220:223], v[180:183], v[76:79]
    v_mfma_f32_16x16x32_bf16 v[80:83], v[216:219], v[184:187], v[80:83]
    ds_read_b128 v[176:179], v18 offset:8192
    v_mfma_f32_16x16x32_bf16 v[84:87], v[220:223], v[184:187], v[84:87]
    v_mfma_f32_16x16x32_bf16 v[88:91], v[216:219], v[188:191], v[88:91]
    ds_read_b128 v[180:183], v18 offset:9216
    v_mfma_f32_16x16x32_bf16 v[92:95], v[220:223], v[188:191], v[92:95]
    s_nop 1
    ds_read_b128 v[184:187], v18 offset:10240
    ds_read_b128 v[188:191], v18 offset:11264
    s_waitcnt lgkmcnt(9)
    v_mfma_f32_16x16x32_bf16 v[96:99], v[224:227], v[144:147], 0
    v_mfma_f32_16x16x32_bf16 v[100:103], v[228:231], v[144:147], 0
    s_add_u32 m0, s45, 131072
    s_mov_b32 s53, 0
    buffer_load_dwordx4 v28, s[20:23], s53 offen offset:0 nt lds
    v_mfma_f32_16x16x32_bf16 v[104:107], v[224:227], v[148:151], 0
    v_mfma_f32_16x16x32_bf16 v[108:111], v[228:231], v[148:151], 0
    v_mfma_f32_16x16x32_bf16 v[112:115], v[224:227], v[152:155], 0
    ds_read_b128 v[144:147], v18 offset:12288
    v_max3_f32 v12, v48, v49, v50
    v_max3_f32 v12, v12, v51, v52
    v_mfma_f32_16x16x32_bf16 v[116:119], v[228:231], v[152:155], 0
    s_add_u32 m0, s45, 131072
    s_mov_b32 s53, 0
    buffer_load_dwordx4 v29, s[20:23], s53 offen offset:1024 nt lds
    v_max3_f32 v12, v12, v53, v54
    v_max_f32 v12, v12, v55
    s_waitcnt lgkmcnt(7)
    v_mfma_f32_16x16x32_bf16 v[120:123], v[224:227], v[156:159], 0
    ds_read_b128 v[148:151], v18 offset:13312
    v_mul_f32 v43, s57, v12
    v_fma_f32 v48, v48, s56, v43
    v_mfma_f32_16x16x32_bf16 v[124:127], v[228:231], v[156:159], 0
    v_fma_f32 v49, v49, s56, v43
    v_fma_f32 v50, v50, s56, v43
    v_mfma_f32_16x16x32_bf16 v[128:131], v[224:227], v[160:163], 0
    ds_read_b128 v[152:155], v18 offset:14336
    v_exp_f32 v48, v48
    v_fma_f32 v51, v51, s56, v43
    v_mfma_f32_16x16x32_bf16 v[132:135], v[228:231], v[160:163], 0
    v_exp_f32 v49, v49
    v_mfma_f32_16x16x32_bf16 v[136:139], v[224:227], v[164:167], 0
    ds_read_b128 v[156:159], v18 offset:15360
    v_fma_f32 v52, v52, s56, v43
    v_exp_f32 v50, v50
    v_mfma_f32_16x16x32_bf16 v[140:143], v[228:231], v[164:167], 0
    s_add_u32 m0, s45, 133120
    s_mov_b32 s53, 32768
    buffer_load_dwordx4 v28, s[20:23], s53 offen offset:0 nt lds
    v_fma_f32 v53, v53, s56, v43
    v_exp_f32 v51, v51
    s_waitcnt lgkmcnt(7)
    v_mfma_f32_16x16x32_bf16 v[96:99], v[232:235], v[168:171], v[96:99]
    ds_read_b128 v[160:163], v18 offset:16384
    v_add_f32 v1, v48, v49
    v_fma_f32 v54, v54, s56, v43
    v_mfma_f32_16x16x32_bf16 v[100:103], v[236:239], v[168:171], v[100:103]
    v_exp_f32 v52, v52
    v_add_f32 v1, v1, v50
    v_mfma_f32_16x16x32_bf16 v[104:107], v[232:235], v[172:175], v[104:107]
    ds_read_b128 v[164:167], v18 offset:17408
    v_fma_f32 v55, v55, s56, v43
    v_exp_f32 v53, v53
    v_mfma_f32_16x16x32_bf16 v[108:111], v[236:239], v[172:175], v[108:111]
    v_add_f32 v1, v1, v51
    v_mfma_f32_16x16x32_bf16 v[112:115], v[232:235], v[176:179], v[112:115]
    ds_read_b128 v[168:171], v18 offset:18432
    v_exp_f32 v54, v54
    v_add_f32 v1, v1, v52
    v_mfma_f32_16x16x32_bf16 v[116:119], v[236:239], v[176:179], v[116:119]
    s_add_u32 m0, s45, 133120
    s_mov_b32 s53, 32768
    buffer_load_dwordx4 v29, s[20:23], s53 offen offset:1024 nt lds
    v_exp_f32 v55, v55
    v_add_f32 v1, v1, v53
    s_waitcnt lgkmcnt(7)
    v_mfma_f32_16x16x32_bf16 v[120:123], v[232:235], v[180:183], v[120:123]
    ds_read_b128 v[172:175], v18 offset:19456
    v_add_f32 v1, v1, v54
    v_add_f32 v1, v1, v55
    v_mfma_f32_16x16x32_bf16 v[124:127], v[236:239], v[180:183], v[124:127]
    v_max3_f32 v13, v56, v57, v58
    v_max3_f32 v13, v13, v59, v60
    v_mfma_f32_16x16x32_bf16 v[128:131], v[232:235], v[184:187], v[128:131]
    ds_read_b128 v[176:179], v18 offset:20480
    v_max3_f32 v13, v13, v61, v62
    v_max_f32 v13, v13, v63
    v_mfma_f32_16x16x32_bf16 v[132:135], v[236:239], v[184:187], v[132:135]
    v_mul_f32 v43, s57, v13
    v_mfma_f32_16x16x32_bf16 v[136:139], v[232:235], v[188:191], v[136:139]
    ds_read_b128 v[180:183], v18 offset:21504
    v_fma_f32 v56, v56, s56, v43
    v_fma_f32 v57, v57, s56, v43
    v_mfma_f32_16x16x32_bf16 v[140:143], v[236:239], v[188:191], v[140:143]
    v_fma_f32 v58, v58, s56, v43
    v_exp_f32 v56, v56
    s_nop 1
    ds_read_b128 v[184:187], v18 offset:22528
    ds_read_b128 v[188:191], v18 offset:23552
    s_waitcnt vmcnt(8)
    ds_read_b128 v[224:227], v20 offset:0
    ds_read_b128 v[228:231], v20 offset:2048
    ds_read_b128 v[232:235], v21 offset:0
    ds_read_b128 v[236:239], v21 offset:2048
    s_waitcnt lgkmcnt(0)
    v_mfma_f32_16x16x32_bf16 v[96:99], v[240:243], v[144:147], v[96:99]
    v_fma_f32 v59, v59, s56, v43
    v_exp_f32 v57, v57
    v_mfma_f32_16x16x32_bf16 v[100:103], v[244:247], v[144:147], v[100:103]
    v_fma_f32 v60, v60, s56, v43
    v_exp_f32 v58, v58
    v_mfma_f32_16x16x32_bf16 v[104:107], v[240:243], v[148:151], v[104:107]
    v_fma_f32 v61, v61, s56, v43
    v_mfma_f32_16x16x32_bf16 v[108:111], v[244:247], v[148:151], v[108:111]
    v_exp_f32 v59, v59
    v_add_f32 v3, v56, v57
    v_mfma_f32_16x16x32_bf16 v[112:115], v[240:243], v[152:155], v[112:115]
    ds_read_b128 v[144:147], v18 offset:24576
    v_fma_f32 v62, v62, s56, v43
    v_exp_f32 v60, v60
    v_mfma_f32_16x16x32_bf16 v[116:119], v[244:247], v[152:155], v[116:119]
    v_add_f32 v3, v3, v58
    v_fma_f32 v63, v63, s56, v43
    v_mfma_f32_16x16x32_bf16 v[120:123], v[240:243], v[156:159], v[120:123]
    ds_read_b128 v[148:151], v18 offset:25600
    v_exp_f32 v61, v61
    v_add_f32 v3, v3, v59
    v_mfma_f32_16x16x32_bf16 v[124:127], v[244:247], v[156:159], v[124:127]
    v_exp_f32 v62, v62
    v_add_f32 v3, v3, v60
    v_mfma_f32_16x16x32_bf16 v[128:131], v[240:243], v[160:163], v[128:131]
    ds_read_b128 v[152:155], v18 offset:26624
    v_exp_f32 v63, v63
    v_mfma_f32_16x16x32_bf16 v[132:135], v[244:247], v[160:163], v[132:135]
    v_add_f32 v3, v3, v61
    v_add_f32 v3, v3, v62
    v_mfma_f32_16x16x32_bf16 v[136:139], v[240:243], v[164:167], v[136:139]
    ds_read_b128 v[156:159], v18 offset:27648
    v_add_f32 v3, v3, v63
    v_max3_f32 v14, v64, v65, v66
    v_mfma_f32_16x16x32_bf16 v[140:143], v[244:247], v[164:167], v[140:143]
    v_max3_f32 v14, v14, v67, v68
    v_max3_f32 v14, v14, v69, v70
    v_mfma_f32_16x16x32_bf16 v[96:99], v[248:251], v[168:171], v[96:99]
    ds_read_b128 v[160:163], v18 offset:28672
    v_max_f32 v14, v14, v71
    v_mul_f32 v43, s57, v14
    v_mfma_f32_16x16x32_bf16 v[100:103], v[252:255], v[168:171], v[100:103]
    v_fma_f32 v64, v64, s56, v43
    v_fma_f32 v65, v65, s56, v43
    v_mfma_f32_16x16x32_bf16 v[104:107], v[248:251], v[172:175], v[104:107]
    ds_read_b128 v[164:167], v18 offset:29696
    v_fma_f32 v66, v66, s56, v43
    v_mfma_f32_16x16x32_bf16 v[108:111], v[252:255], v[172:175], v[108:111]
    v_exp_f32 v64, v64
    v_fma_f32 v67, v67, s56, v43
    v_mfma_f32_16x16x32_bf16 v[112:115], v[248:251], v[176:179], v[112:115]
    ds_read_b128 v[168:171], v18 offset:30720
    v_exp_f32 v65, v65
    v_fma_f32 v68, v68, s56, v43
    v_mfma_f32_16x16x32_bf16 v[116:119], v[252:255], v[176:179], v[116:119]
    v_exp_f32 v66, v66
    v_fma_f32 v69, v69, s56, v43
    v_mfma_f32_16x16x32_bf16 v[120:123], v[248:251], v[180:183], v[120:123]
    ds_read_b128 v[172:175], v18 offset:31744
    v_exp_f32 v67, v67
    v_add_f32 v4, v64, v65
    v_mfma_f32_16x16x32_bf16 v[124:127], v[252:255], v[180:183], v[124:127]
    v_fma_f32 v70, v70, s56, v43
    v_exp_f32 v68, v68
    v_mfma_f32_16x16x32_bf16 v[128:131], v[248:251], v[184:187], v[128:131]
    ds_read_b128 v[176:179], v18 offset:32768
    v_add_f32 v4, v4, v66
    v_mfma_f32_16x16x32_bf16 v[132:135], v[252:255], v[184:187], v[132:135]
    v_fma_f32 v71, v71, s56, v43
    v_exp_f32 v69, v69
    v_mfma_f32_16x16x32_bf16 v[136:139], v[248:251], v[188:191], v[136:139]
    ds_read_b128 v[180:183], v18 offset:33792
    v_add_f32 v4, v4, v67
    v_exp_f32 v70, v70
    v_mfma_f32_16x16x32_bf16 v[140:143], v[252:255], v[188:191], v[140:143]
    v_add_f32 v4, v4, v68
    v_exp_f32 v71, v71
    s_nop 1
    ds_read_b128 v[184:187], v18 offset:34816
    ds_read_b128 v[188:191], v18 offset:35840
    s_waitcnt vmcnt(4)
    ds_read_b128 v[240:243], v20 offset:32768
    ds_read_b128 v[244:247], v20 offset:34816
    ds_read_b128 v[248:251], v21 offset:32768
    ds_read_b128 v[252:255], v21 offset:34816
    s_waitcnt lgkmcnt(0)
    v_mfma_f32_16x16x32_bf16 v[96:99], v[224:227], v[144:147], v[96:99]
    v_add_f32 v4, v4, v69
    v_add_f32 v4, v4, v70
    v_mfma_f32_16x16x32_bf16 v[100:103], v[228:231], v[144:147], v[100:103]
    s_add_u32 m0, s45, 98304
    s_mov_b32 s53, 65536
    buffer_load_dwordx4 v28, s[20:23], s53 offen offset:0 nt lds
    v_add_f32 v4, v4, v71
    v_mfma_f32_16x16x32_bf16 v[104:107], v[224:227], v[148:151], v[104:107]
    v_max3_f32 v15, v72, v73, v74
    v_max3_f32 v15, v15, v75, v76
    v_mfma_f32_16x16x32_bf16 v[108:111], v[228:231], v[148:151], v[108:111]
    v_max3_f32 v15, v15, v77, v78
    v_max_f32 v15, v15, v79
    v_mfma_f32_16x16x32_bf16 v[112:115], v[224:227], v[152:155], v[112:115]
    ds_read_b128 v[144:147], v18 offset:36864
    v_mul_f32 v43, s57, v15
    v_fma_f32 v72, v72, s56, v43
    v_mfma_f32_16x16x32_bf16 v[116:119], v[228:231], v[152:155], v[116:119]
    s_add_u32 m0, s45, 98304
    s_mov_b32 s53, 65536
    buffer_load_dwordx4 v29, s[20:23], s53 offen offset:1024 nt lds
    v_fma_f32 v73, v73, s56, v43
    v_fma_f32 v74, v74, s56, v43
    v_mfma_f32_16x16x32_bf16 v[120:123], v[224:227], v[156:159], v[120:123]
    ds_read_b128 v[148:151], v18 offset:37888
    v_exp_f32 v72, v72
    v_fma_f32 v75, v75, s56, v43
    v_mfma_f32_16x16x32_bf16 v[124:127], v[228:231], v[156:159], v[124:127]
    v_exp_f32 v73, v73
    v_mfma_f32_16x16x32_bf16 v[128:131], v[224:227], v[160:163], v[128:131]
    ds_read_b128 v[152:155], v18 offset:38912
    v_fma_f32 v76, v76, s56, v43
    v_exp_f32 v74, v74
    v_mfma_f32_16x16x32_bf16 v[132:135], v[228:231], v[160:163], v[132:135]
    v_fma_f32 v77, v77, s56, v43
    v_exp_f32 v75, v75
    v_mfma_f32_16x16x32_bf16 v[136:139], v[224:227], v[164:167], v[136:139]
    ds_read_b128 v[156:159], v18 offset:39936
    v_add_f32 v5, v72, v73
    v_fma_f32 v78, v78, s56, v43
    v_mfma_f32_16x16x32_bf16 v[140:143], v[228:231], v[164:167], v[140:143]
    s_add_u32 m0, s45, 100352
    s_mov_b32 s53, 98304
    buffer_load_dwordx4 v28, s[20:23], s53 offen offset:0 nt lds
    v_exp_f32 v76, v76
    v_add_f32 v5, v5, v74
    v_mfma_f32_16x16x32_bf16 v[96:99], v[232:235], v[168:171], v[96:99]
    ds_read_b128 v[160:163], v18 offset:40960
    v_fma_f32 v79, v79, s56, v43
    v_exp_f32 v77, v77
    v_mfma_f32_16x16x32_bf16 v[100:103], v[236:239], v[168:171], v[100:103]
    v_add_f32 v5, v5, v75
    v_mfma_f32_16x16x32_bf16 v[104:107], v[232:235], v[172:175], v[104:107]
    ds_read_b128 v[164:167], v18 offset:41984
    v_exp_f32 v78, v78
    v_add_f32 v5, v5, v76
    v_mfma_f32_16x16x32_bf16 v[108:111], v[236:239], v[172:175], v[108:111]
    v_exp_f32 v79, v79
    v_add_f32 v5, v5, v77
    v_mfma_f32_16x16x32_bf16 v[112:115], v[232:235], v[176:179], v[112:115]
    ds_read_b128 v[168:171], v18 offset:43008
    v_add_f32 v5, v5, v78
    v_add_f32 v5, v5, v79
    v_mfma_f32_16x16x32_bf16 v[116:119], v[236:239], v[176:179], v[116:119]
    s_add_u32 m0, s45, 100352
    s_mov_b32 s53, 98304
    buffer_load_dwordx4 v29, s[20:23], s53 offen offset:1024 nt lds
    v_max3_f32 v16, v80, v81, v82
    v_max3_f32 v16, v16, v83, v84
    v_mfma_f32_16x16x32_bf16 v[120:123], v[232:235], v[180:183], v[120:123]
    ds_read_b128 v[172:175], v18 offset:44032
    v_max3_f32 v16, v16, v85, v86
    v_max_f32 v16, v16, v87
    v_mfma_f32_16x16x32_bf16 v[124:127], v[236:239], v[180:183], v[124:127]
    v_mul_f32 v43, s57, v16
    v_mfma_f32_16x16x32_bf16 v[128:131], v[232:235], v[184:187], v[128:131]
    ds_read_b128 v[176:179], v18 offset:45056
    v_fma_f32 v80, v80, s56, v43
    v_fma_f32 v81, v81, s56, v43
    v_mfma_f32_16x16x32_bf16 v[132:135], v[236:239], v[184:187], v[132:135]
    v_fma_f32 v82, v82, s56, v43
    v_exp_f32 v80, v80
    v_mfma_f32_16x16x32_bf16 v[136:139], v[232:235], v[188:191], v[136:139]
    ds_read_b128 v[180:183], v18 offset:46080
    v_fma_f32 v83, v83, s56, v43
    v_exp_f32 v81, v81
    v_mfma_f32_16x16x32_bf16 v[140:143], v[236:239], v[188:191], v[140:143]
    v_fma_f32 v84, v84, s56, v43
    v_exp_f32 v82, v82
    s_nop 1
    ds_read_b128 v[184:187], v18 offset:47104
    ds_read_b128 v[188:191], v18 offset:48128
    s_waitcnt lgkmcnt(9)
    v_mfma_f32_16x16x32_bf16 v[96:99], v[240:243], v[144:147], v[96:99]
    v_fma_f32 v85, v85, s56, v43
    v_mfma_f32_16x16x32_bf16 v[100:103], v[244:247], v[144:147], v[100:103]
    s_add_u32 s53, s59, 0
    s_and_b32 s53, s53, 15
    s_mul_i32 s53, s53, 14336
    buffer_load_dwordx4 v[192:195], v31, s[24:27], s53 offen offset:0
    v_exp_f32 v83, v83
    v_add_f32 v6, v80, v81
    v_mfma_f32_16x16x32_bf16 v[104:107], v[240:243], v[148:151], v[104:107]
    v_fma_f32 v86, v86, s56, v43
    v_exp_f32 v84, v84
    v_mfma_f32_16x16x32_bf16 v[108:111], v[244:247], v[148:151], v[108:111]
    v_add_f32 v6, v6, v82
    v_fma_f32 v87, v87, s56, v43
    v_mfma_f32_16x16x32_bf16 v[112:115], v[240:243], v[152:155], v[112:115]
    v_exp_f32 v85, v85
    v_add_f32 v6, v6, v83
    v_mfma_f32_16x16x32_bf16 v[116:119], v[244:247], v[152:155], v[116:119]
    s_add_u32 s53, s59, 0
    s_and_b32 s53, s53, 15
    s_mul_i32 s53, s53, 14336
    buffer_load_dwordx4 v[196:199], v32, s[24:27], s53 offen offset:1024
    v_exp_f32 v86, v86
    v_add_f32 v6, v6, v84
    s_waitcnt lgkmcnt(6)
    v_mfma_f32_16x16x32_bf16 v[120:123], v[240:243], v[156:159], v[120:123]
    v_exp_f32 v87, v87
    v_mfma_f32_16x16x32_bf16 v[124:127], v[244:247], v[156:159], v[124:127]
    v_add_f32 v6, v6, v85
    v_add_f32 v6, v6, v86
    v_mfma_f32_16x16x32_bf16 v[128:131], v[240:243], v[160:163], v[128:131]
    v_add_f32 v6, v6, v87
    v_max3_f32 v17, v88, v89, v90
    v_mfma_f32_16x16x32_bf16 v[132:135], v[244:247], v[160:163], v[132:135]
    v_max3_f32 v17, v17, v91, v92
    v_max3_f32 v17, v17, v93, v94
    v_mfma_f32_16x16x32_bf16 v[136:139], v[240:243], v[164:167], v[136:139]
    v_max_f32 v17, v17, v95
    v_mul_f32 v43, s57, v17
    v_mfma_f32_16x16x32_bf16 v[140:143], v[244:247], v[164:167], v[140:143]
    s_add_u32 s53, s59, 1
    s_and_b32 s53, s53, 15
    s_mul_i32 s53, s53, 14336
    buffer_load_dwordx4 v[200:203], v31, s[24:27], s53 offen offset:0
    v_fma_f32 v88, v88, s56, v43
    v_fma_f32 v89, v89, s56, v43
    s_waitcnt lgkmcnt(3)
    v_mfma_f32_16x16x32_bf16 v[96:99], v[248:251], v[168:171], v[96:99]
    v_fma_f32 v90, v90, s56, v43
    v_mfma_f32_16x16x32_bf16 v[100:103], v[252:255], v[168:171], v[100:103]
    v_exp_f32 v88, v88
    v_fma_f32 v91, v91, s56, v43
    v_mfma_f32_16x16x32_bf16 v[104:107], v[248:251], v[172:175], v[104:107]
    v_exp_f32 v89, v89
    v_fma_f32 v92, v92, s56, v43
    v_mfma_f32_16x16x32_bf16 v[108:111], v[252:255], v[172:175], v[108:111]
    v_exp_f32 v90, v90
    v_fma_f32 v93, v93, s56, v43
    v_mfma_f32_16x16x32_bf16 v[112:115], v[248:251], v[176:179], v[112:115]
    v_exp_f32 v91, v91
    v_add_f32 v7, v88, v89
    v_mfma_f32_16x16x32_bf16 v[116:119], v[252:255], v[176:179], v[116:119]
    s_add_u32 s53, s59, 1
    s_and_b32 s53, s53, 15
    s_mul_i32 s53, s53, 14336
    buffer_load_dwordx4 v[204:207], v32, s[24:27], s53 offen offset:1024
    v_fma_f32 v94, v94, s56, v43
    v_exp_f32 v92, v92
    s_waitcnt lgkmcnt(0)
    v_mfma_f32_16x16x32_bf16 v[120:123], v[248:251], v[180:183], v[120:123]
    v_add_f32 v7, v7, v90
    v_mfma_f32_16x16x32_bf16 v[124:127], v[252:255], v[180:183], v[124:127]
    v_fma_f32 v95, v95, s56, v43
    v_exp_f32 v93, v93
    v_mfma_f32_16x16x32_bf16 v[128:131], v[248:251], v[184:187], v[128:131]
    v_add_f32 v7, v7, v91
    v_exp_f32 v94, v94
    v_mfma_f32_16x16x32_bf16 v[132:135], v[252:255], v[184:187], v[132:135]
    v_add_f32 v7, v7, v92
    v_exp_f32 v95, v95
    v_mfma_f32_16x16x32_bf16 v[136:139], v[248:251], v[188:191], v[136:139]
    v_add_f32 v7, v7, v93
    v_add_f32 v7, v7, v94
    v_mfma_f32_16x16x32_bf16 v[140:143], v[252:255], v[188:191], v[140:143]
    v_add_f32 v7, v7, v95
L_join:
    v_max3_f32 v20, v96, v97, v98
    v_max3_f32 v20, v20, v99, v100
    v_max3_f32 v20, v20, v101, v102
    v_max_f32 v20, v20, v103
    v_max_f32 v20, v20, v12
    v_max3_f32 v21, v104, v105, v106
    v_max3_f32 v21, v21, v107, v108
    v_max3_f32 v21, v21, v109, v110
    v_max_f32 v21, v21, v111
    v_max_f32 v21, v21, v13
    v_max3_f32 v22, v112, v113, v114
    v_max3_f32 v22, v22, v115, v116
    v_max3_f32 v22, v22, v117, v118
    v_max_f32 v22, v22, v119
    v_max_f32 v22, v22, v14
    v_max3_f32 v23, v120, v121, v122
    v_max3_f32 v23, v23, v123, v124
    v_max3_f32 v23, v23, v125, v126
    v_max_f32 v23, v23, v127
    v_max_f32 v23, v23, v15
    v_max3_f32 v10, v128, v129, v130
    v_max3_f32 v10, v10, v131, v132
    v_max3_f32 v10, v10, v133, v134
    v_max_f32 v10, v10, v135
    v_max_f32 v10, v10, v16
    v_max3_f32 v11, v136, v137, v138
    v_max3_f32 v11, v11, v139, v140
    v_max3_f32 v11, v11, v141, v142
    v_max_f32 v11, v11, v143
    v_max_f32 v11, v11, v17
    s_nop 1
    v_permlane32_swap_b32 v20, v21
    v_permlane32_swap_b32 v22, v23
    v_permlane32_swap_b32 v10, v11
    s_nop 1
    v_max_f32 v20, v20, v21
    v_max_f32 v22, v22, v23
    v_max_f32 v10, v10, v11
    v_mov_b32 v43, v10
    s_nop 1
    v_permlane16_swap_b32 v20, v22
    v_permlane16_swap_b32 v10, v43
    s_nop 1
    v_max_f32 v20, v20, v22
    v_max_f32 v10, v10, v43
    ds_write_b32 v27, v20
    ds_write_b32 v37, v10
    s_add_u32 s53, s59, 2
    s_and_b32 s53, s53, 15
    s_mul_i32 s53, s53, 14336
    buffer_load_dwordx4 v[208:211], v31, s[24:27], s53 offen offset:0
    buffer_load_dwordx4 v[212:215], v32, s[24:27], s53 offen offset:1024
    s_add_u32 s53, s59, 3
    s_and_b32 s53, s53, 15
    s_mul_i32 s53, s53, 14336
    buffer_load_dwordx4 v[216:219], v31, s[24:27], s53 offen offset:0
    buffer_load_dwordx4 v[220:223], v32, s[24:27], s53 offen offset:1024
    s_waitcnt lgkmcnt(0)
    s_barrier
    ds_read_b128 v[144:147], v25 offset:0
    ds_read_b128 v[148:151], v25 offset:16
    ds_read_b128 v[152:155], v26 offset:0
    ds_read_b128 v[156:159], v26 offset:16
    s_waitcnt lgkmcnt(2)
    v_max3_f32 v144, v144, v145, v146
    v_max3_f32 v144, v144, v147, v148
    v_max3_f32 v144, v144, v149, v150
    v_max_f32 v144, v144, v151
    v_mul_f32 v44, s57, v144
    s_waitcnt lgkmcnt(0)
    v_max3_f32 v152, v152, v153, v154
    v_max3_f32 v152, v152, v155, v156
    v_max3_f32 v152, v152, v157, v158
    v_max_f32 v152, v152, v159
    v_mul_f32 v8, s57, v152
    v_mov_b32 v46, v44
    v_mov_b32 v9, v8
    s_nop 1
    v_permlane16_swap_b32 v44, v46
    v_permlane32_swap_b32 v8, v9
    s_nop 1
    v_mov_b32 v45, v44
    v_mov_b32 v47, v46
    s_nop 1
    v_permlane32_swap_b32 v44, v45
    v_permlane32_swap_b32 v46, v47
    s_nop 1
    v_fma_f32 v12, v12, s56, v44
    v_fma_f32 v13, v13, s56, v45
    v_fma_f32 v14, v14, s56, v46
    v_fma_f32 v15, v15, s56, v47
    v_fma_f32 v16, v16, s56, v8
    v_fma_f32 v17, v17, s56, v9
    v_exp_f32 v12, v12
    v_exp_f32 v13, v13
    v_exp_f32 v14, v14
    v_exp_f32 v15, v15
    v_exp_f32 v16, v16
    v_exp_f32 v17, v17
    v_pk_mul_f32 v[48:49], v[48:49], v[12:13] op_sel_hi:[1,0]
    v_pk_mul_f32 v[50:51], v[50:51], v[12:13] op_sel_hi:[1,0]
    v_pk_mul_f32 v[52:53], v[52:53], v[12:13] op_sel_hi:[1,0]
    v_pk_mul_f32 v[54:55], v[54:55], v[12:13] op_sel_hi:[1,0]
    v_cvt_pk_bf16_f32 v48, v48, v49
    v_cvt_pk_bf16_f32 v49, v50, v51
    v_cvt_pk_bf16_f32 v50, v52, v53
    v_cvt_pk_bf16_f32 v51, v54, v55
    ds_write_b128 v39, v[48:51] offset:0
    v_mul_f32 v1, v1, v12
    v_pk_mul_f32 v[56:57], v[56:57], v[12:13] op_sel:[0,1] op_sel_hi:[1,1]
    v_pk_mul_f32 v[58:59], v[58:59], v[12:13] op_sel:[0,1] op_sel_hi:[1,1]
    v_pk_mul_f32 v[60:61], v[60:61], v[12:13] op_sel:[0,1] op_sel_hi:[1,1]
    v_pk_mul_f32 v[62:63], v[62:63], v[12:13] op_sel:[0,1] op_sel_hi:[1,1]
    v_cvt_pk_bf16_f32 v56, v56, v57
    v_cvt_pk_bf16_f32 v57, v58, v59
    v_cvt_pk_bf16_f32 v58, v60, v61
    v_cvt_pk_bf16_f32 v59, v62, v63
    ds_write_b128 v39, v[56:59] offset:1024
    v_mul_f32 v3, v3, v13
    v_pk_mul_f32 v[64:65], v[64:65], v[14:15] op_sel_hi:[1,0]
    v_pk_mul_f32 v[66:67], v[66:67], v[14:15] op_sel_hi:[1,0]
    v_pk_mul_f32 v[68:69], v[68:69], v[14:15] op_sel_hi:[1,0]
    v_pk_mul_f32 v[70:71], v[70:71], v[14:15] op_sel_hi:[1,0]
    v_cvt_pk_bf16_f32 v64, v64, v65
    v_cvt_pk_bf16_f32 v65, v66, v67
    v_cvt_pk_bf16_f32 v66, v68, v69
    v_cvt_pk_bf16_f32 v67, v70, v71
    ds_write_b128 v39, v[64:67] offset:2048
    v_mul_f32 v4, v4, v14
    v_pk_mul_f32 v[72:73], v[72:73], v[14:15] op_sel:[0,1] op_sel_hi:[1,1]
    v_pk_mul_f32 v[74:75], v[74:75], v[14:15] op_sel:[0,1] op_sel_hi:[1,1]
    v_pk_mul_f32 v[76:77], v[76:77], v[14:15] op_sel:[0,1] op_sel_hi:[1,1]
    v_pk_mul_f32 v[78:79], v[78:79], v[14:15] op_sel:[0,1] op_sel_hi:[1,1]
    v_cvt_pk_bf16_f32 v72, v72, v73
    v_cvt_pk_bf16_f32 v73, v74, v75
    v_cvt_pk_bf16_f32 v74, v76, v77
    v_cvt_pk_bf16_f32 v75, v78, v79
    ds_write_b128 v39, v[72:75] offset:3072
    v_mul_f32 v5, v5, v15
    v_pk_mul_f32 v[80:81], v[80:81], v[16:17] op_sel_hi:[1,0]
    v_pk_mul_f32 v[82:83], v[82:83], v[16:17] op_sel_hi:[1,0]
    v_pk_mul_f32 v[84:85], v[84:85], v[16:17] op_sel_hi:[1,0]
    v_pk_mul_f32 v[86:87], v[86:87], v[16:17] op_sel_hi:[1,0]
    v_cvt_pk_bf16_f32 v80, v80, v81
    v_cvt_pk_bf16_f32 v81, v82, v83
    v_cvt_pk_bf16_f32 v82, v84, v85
    v_cvt_pk_bf16_f32 v83, v86, v87
    ds_write_b128 v39, v[80:83] offset:4096
    v_mul_f32 v6, v6, v16
    v_pk_mul_f32 v[88:89], v[88:89], v[16:17] op_sel:[0,1] op_sel_hi:[1,1]
    v_pk_mul_f32 v[90:91], v[90:91], v[16:17] op_sel:[0,1] op_sel_hi:[1,1]
    v_pk_mul_f32 v[92:93], v[92:93], v[16:17] op_sel:[0,1] op_sel_hi:[1,1]
    v_pk_mul_f32 v[94:95], v[94:95], v[16:17] op_sel:[0,1] op_sel_hi:[1,1]
    v_cvt_pk_bf16_f32 v88, v88, v89
    v_cvt_pk_bf16_f32 v89, v90, v91
    v_cvt_pk_bf16_f32 v90, v92, v93
    v_cvt_pk_bf16_f32 v91, v94, v95
    ds_write_b128 v39, v[88:91] offset:5120
    v_mul_f32 v7, v7, v17
    s_add_u32 s53, s59, 4
    s_and_b32 s53, s53, 15
    s_mul_i32 s53, s53, 14336
    buffer_load_dwordx4 v[224:227], v31, s[24:27], s53 offen offset:0
    buffer_load_dwordx4 v[228:231], v32, s[24:27], s53 offen offset:1024
    s_add_u32 s53, s59, 5
    s_and_b32 s53, s53, 15
    s_mul_i32 s53, s53, 14336
    buffer_load_dwordx4 v[232:235], v31, s[24:27], s53 offen offset:0
    buffer_load_dwordx4 v[236:239], v32, s[24:27], s53 offen offset:1024
    s_waitcnt lgkmcnt(0)
    s_waitcnt vmcnt(18)
    s_barrier
    ds_read_b64_tr_b16 v[240:241], v30 offset:32768
    ds_read_b64_tr_b16 v[242:243], v30 offset:49152
    ds_read_b64_tr_b16 v[244:245], v38 offset:32768
    ds_read_b64_tr_b16 v[246:247], v38 offset:49152
    ds_read_b128 v[144:147], v18 offset:0
    ds_read_b128 v[148:151], v18 offset:1024
    ds_read_b128 v[152:155], v18 offset:2048
    ds_read_b128 v[156:159], v18 offset:3072
    ds_read_b128 v[160:163], v18 offset:4096
    ds_read_b128 v[164:167], v18 offset:5120
    s_waitcnt lgkmcnt(0)
    s_barrier
    v_mfma_f32_16x16x32_bf16 v[48:51], v[240:243], v[144:147], 0
    v_fma_f32 v96, v96, s56, v44
    v_fma_f32 v97, v97, s56, v44
    v_fma_f32 v98, v98, s56, v44
    v_exp_f32 v96, v96
    v_mfma_f32_16x16x32_bf16 v[56:59], v[240:243], v[148:151], 0
    v_fma_f32 v99, v99, s56, v44
    v_exp_f32 v97, v97
    v_fma_f32 v100, v100, s56, v44
    s_add_u32 m0, s45, 131072
    s_mov_b32 s53, 131072
    buffer_load_dwordx4 v28, s[20:23], s53 offen offset:0 nt lds
    buffer_load_dwordx4 v29, s[20:23], s53 offen offset:1024 nt lds
    ds_read_b128 v[168:171], v18 offset:6144
    ds_read_b128 v[172:175], v18 offset:7168
    ds_read_b128 v[176:179], v18 offset:8192
    v_mfma_f32_16x16x32_bf16 v[64:67], v[240:243], v[152:155], 0
    v_exp_f32 v98, v98
    v_add_f32 v1, v1, v96
    v_fma_f32 v101, v101, s56, v44
    v_mfma_f32_16x16x32_bf16 v[72:75], v[240:243], v[156:159], 0
    v_exp_f32 v99, v99
    v_add_f32 v1, v1, v97
    v_fma_f32 v102, v102, s56, v44
    ds_read_b128 v[180:183], v18 offset:9216
    ds_read_b128 v[184:187], v18 offset:10240
    ds_read_b128 v[188:191], v18 offset:11264
    v_mfma_f32_16x16x32_bf16 v[80:83], v[240:243], v[160:163], 0
    v_exp_f32 v100, v100
    v_add_f32 v1, v1, v98
    v_fma_f32 v103, v103, s56, v44
    v_exp_f32 v101, v101
    v_mfma_f32_16x16x32_bf16 v[88:91], v[240:243], v[164:167], 0
    v_add_f32 v1, v1, v99
    v_exp_f32 v102, v102
    v_add_f32 v1, v1, v100
    s_waitcnt vmcnt(18)
    s_barrier
    v_mfma_f32_16x16x32_bf16 v[52:55], v[244:247], v[144:147], 0
    v_exp_f32 v103, v103
    v_add_f32 v1, v1, v101
    v_add_f32 v1, v1, v102
    ds_read_b64_tr_b16 v[240:241], v30 offset:34816
    ds_read_b64_tr_b16 v[242:243], v30 offset:51200
    v_mfma_f32_16x16x32_bf16 v[60:63], v[244:247], v[148:151], 0
    v_add_f32 v1, v1, v103
    v_cvt_pk_bf16_f32 v96, v96, v97
    v_cvt_pk_bf16_f32 v97, v98, v99
    ds_read_b64_tr_b16 v[248:249], v38 offset:34816
    ds_read_b64_tr_b16 v[250:251], v38 offset:51200
    v_mfma_f32_16x16x32_bf16 v[68:71], v[244:247], v[152:155], 0
    v_cvt_pk_bf16_f32 v98, v100, v101
    v_cvt_pk_bf16_f32 v99, v102, v103
    ds_write_b128 v39, v[96:99] offset:49152
    v_mfma_f32_16x16x32_bf16 v[76:79], v[244:247], v[156:159], 0
    v_fma_f32 v104, v104, s56, v45
    v_fma_f32 v105, v105, s56, v45
    v_fma_f32 v106, v106, s56, v45
    v_exp_f32 v104, v104
    v_mfma_f32_16x16x32_bf16 v[84:87], v[244:247], v[160:163], 0
    v_fma_f32 v107, v107, s56, v45
    v_exp_f32 v105, v105
    v_fma_f32 v108, v108, s56, v45
    v_mfma_f32_16x16x32_bf16 v[92:95], v[244:247], v[164:167], 0
    v_exp_f32 v106, v106
    v_add_f32 v3, v3, v104
    v_fma_f32 v109, v109, s56, v45
    s_waitcnt lgkmcnt(1)
    s_barrier
    v_mfma_f32_16x16x32_bf16 v[48:51], v[240:243], v[168:171], v[48:51]
    v_exp_f32 v107, v107
    v_add_f32 v3, v3, v105
    v_fma_f32 v110, v110, s56, v45
    v_mfma_f32_16x16x32_bf16 v[56:59], v[240:243], v[172:175], v[56:59]
    v_exp_f32 v108, v108
    v_add_f32 v3, v3, v106
    v_fma_f32 v111, v111, s56, v45
    v_exp_f32 v109, v109
    s_add_u32 m0, s45, 133120
    s_mov_b32 s53, 163840
    buffer_load_dwordx4 v28, s[20:23], s53 offen offset:0 nt lds
    buffer_load_dwordx4 v29, s[20:23], s53 offen offset:1024 nt lds
    ds_read_b128 v[144:147], v18 offset:12288
    ds_read_b128 v[148:151], v18 offset:13312
    ds_read_b128 v[152:155], v18 offset:14336
    v_mfma_f32_16x16x32_bf16 v[64:67], v[240:243], v[176:179], v[64:67]
    v_add_f32 v3, v3, v107
    v_exp_f32 v110, v110
    v_add_f32 v3, v3, v108
    v_mfma_f32_16x16x32_bf16 v[72:75], v[240:243], v[180:183], v[72:75]
    v_exp_f32 v111, v111
    v_add_f32 v3, v3, v109
    v_add_f32 v3, v3, v110
    ds_read_b128 v[156:159], v18 offset:15360
    ds_read_b128 v[160:163], v18 offset:16384
    ds_read_b128 v[164:167], v18 offset:17408
    v_mfma_f32_16x16x32_bf16 v[80:83], v[240:243], v[184:187], v[80:83]
    v_add_f32 v3, v3, v111
    v_cvt_pk_bf16_f32 v104, v104, v105
    v_cvt_pk_bf16_f32 v105, v106, v107
    v_mfma_f32_16x16x32_bf16 v[88:91], v[240:243], v[188:191], v[88:91]
    v_cvt_pk_bf16_f32 v106, v108, v109
    v_cvt_pk_bf16_f32 v107, v110, v111
    ds_write_b128 v39, v[104:107] offset:50176
    s_waitcnt vmcnt(18)
    s_barrier
    v_mfma_f32_16x16x32_bf16 v[52:55], v[248:251], v[168:171], v[52:55]
    v_fma_f32 v112, v112, s56, v46
    v_fma_f32 v113, v113, s56, v46
    v_fma_f32 v114, v114, s56, v46
    v_exp_f32 v112, v112
    ds_read_b64_tr_b16 v[240:241], v30 offset:0
    ds_read_b64_tr_b16 v[242:243], v30 offset:16384
    v_mfma_f32_16x16x32_bf16 v[60:63], v[248:251], v[172:175], v[60:63]
    v_fma_f32 v115, v115, s56, v46
    v_exp_f32 v113, v113
    v_fma_f32 v116, v116, s56, v46
    ds_read_b64_tr_b16 v[244:245], v38 offset:0
    ds_read_b64_tr_b16 v[246:247], v38 offset:16384
    v_mfma_f32_16x16x32_bf16 v[68:71], v[248:251], v[176:179], v[68:71]
    v_exp_f32 v114, v114
    v_add_f32 v4, v4, v112
    v_fma_f32 v117, v117, s56, v46
    v_mfma_f32_16x16x32_bf16 v[76:79], v[248:251], v[180:183], v[76:79]
    v_exp_f32 v115, v115
    v_add_f32 v4, v4, v113
    v_fma_f32 v118, v118, s56, v46
    v_mfma_f32_16x16x32_bf16 v[84:87], v[248:251], v[184:187], v[84:87]
    v_exp_f32 v116, v116
    v_add_f32 v4, v4, v114
    v_fma_f32 v119, v119, s56, v46
    v_exp_f32 v117, v117
    v_mfma_f32_16x16x32_bf16 v[92:95], v[248:251], v[188:191], v[92:95]
    v_add_f32 v4, v4, v115
    v_exp_f32 v118, v118
    v_add_f32 v4, v4, v116
    s_waitcnt lgkmcnt(0)
    s_barrier
    v_mfma_f32_16x16x32_bf16 v[48:51], v[240:243], v[144:147], v[48:51]
    v_exp_f32 v119, v119
    v_add_f32 v4, v4, v117
    v_add_f32 v4, v4, v118
    v_mfma_f32_16x16x32_bf16 v[56:59], v[240:243], v[148:151], v[56:59]
    v_add_f32 v4, v4, v119
    v_cvt_pk_bf16_f32 v112, v112, v113
    v_cvt_pk_bf16_f32 v113, v114, v115
    s_add_u32 m0, s45, 98304
    s_mov_b32 s53, 196608
    buffer_load_dwordx4 v28, s[20:23], s53 offen offset:0 nt lds
    buffer_load_dwordx4 v29, s[20:23], s53 offen offset:1024 nt lds
    ds_read_b128 v[168:171], v18 offset:18432
    ds_read_b128 v[172:175], v18 offset:19456
    ds_read_b128 v[176:179], v18 offset:20480
    v_mfma_f32_16x16x32_bf16 v[64:67], v[240:243], v[152:155], v[64:67]
    v_cvt_pk_bf16_f32 v114, v116, v117
    v_cvt_pk_bf16_f32 v115, v118, v119
    ds_write_b128 v39, v[112:115] offset:51200
    v_mfma_f32_16x16x32_bf16 v[72:75], v[240:243], v[156:159], v[72:75]
    v_fma_f32 v120, v120, s56, v47
    v_fma_f32 v121, v121, s56, v47
    v_fma_f32 v122, v122, s56, v47
    v_exp_f32 v120, v120
    ds_read_b128 v[180:183], v18 offset:21504
    ds_read_b128 v[184:187], v18 offset:22528
    ds_read_b128 v[188:191], v18 offset:23552
    v_mfma_f32_16x16x32_bf16 v[80:83], v[240:243], v[160:163], v[80:83]
    v_fma_f32 v123, v123, s56, v47
    v_exp_f32 v121, v121
    v_fma_f32 v124, v124, s56, v47
    v_mfma_f32_16x16x32_bf16 v[88:91], v[240:243], v[164:167], v[88:91]
    v_exp_f32 v122, v122
    v_add_f32 v5, v5, v120
    v_fma_f32 v125, v125, s56, v47
    s_waitcnt vmcnt(18)
    s_barrier
    v_mfma_f32_16x16x32_bf16 v[52:55], v[244:247], v[144:147], v[52:55]
    v_exp_f32 v123, v123
    v_add_f32 v5, v5, v121
    v_fma_f32 v126, v126, s56, v47
    ds_read_b64_tr_b16 v[240:241], v30 offset:2048
    ds_read_b64_tr_b16 v[242:243], v30 offset:18432
    v_mfma_f32_16x16x32_bf16 v[60:63], v[244:247], v[148:151], v[60:63]
    v_exp_f32 v124, v124
    v_add_f32 v5, v5, v122
    v_fma_f32 v127, v127, s56, v47
    v_exp_f32 v125, v125
    ds_read_b64_tr_b16 v[248:249], v38 offset:2048
    ds_read_b64_tr_b16 v[250:251], v38 offset:18432
    v_mfma_f32_16x16x32_bf16 v[68:71], v[244:247], v[152:155], v[68:71]
    v_add_f32 v5, v5, v123
    v_exp_f32 v126, v126
    v_add_f32 v5, v5, v124
    v_mfma_f32_16x16x32_bf16 v[76:79], v[244:247], v[156:159], v[76:79]
    v_exp_f32 v127, v127
    v_add_f32 v5, v5, v125
    v_add_f32 v5, v5, v126
    v_mfma_f32_16x16x32_bf16 v[84:87], v[244:247], v[160:163], v[84:87]
    v_add_f32 v5, v5, v127
    v_cvt_pk_bf16_f32 v120, v120, v121
    v_cvt_pk_bf16_f32 v121, v122, v123
    v_mfma_f32_16x16x32_bf16 v[92:95], v[244:247], v[164:167], v[92:95]
    v_cvt_pk_bf16_f32 v122, v124, v125
    v_cvt_pk_bf16_f32 v123, v126, v127
    ds_write_b128 v39, v[120:123] offset:52224
    s_waitcnt lgkmcnt(1)
    s_barrier
    v_mfma_f32_16x16x32_bf16 v[48:51], v[240:243], v[168:171], v[48:51]
    v_fma_f32 v128, v128, s56, v8
    v_fma_f32 v129, v129, s56, v8
    v_fma_f32 v130, v130, s56, v8
    v_exp_f32 v128, v128
    v_mfma_f32_16x16x32_bf16 v[56:59], v[240:243], v[172:175], v[56:59]
    v_fma_f32 v131, v131, s56, v8
    v_exp_f32 v129, v129
    v_fma_f32 v132, v132, s56, v8
    s_add_u32 m0, s45, 100352
    s_mov_b32 s53, 229376
    buffer_load_dwordx4 v28, s[20:23], s53 offen offset:0 nt lds
    buffer_load_dwordx4 v29, s[20:23], s53 offen offset:1024 nt lds
    ds_read_b128 v[144:147], v18 offset:24576
    ds_read_b128 v[148:151], v18 offset:25600
    ds_read_b128 v[152:155], v18 offset:26624
    v_mfma_f32_16x16x32_bf16 v[64:67], v[240:243], v[176:179], v[64:67]
    v_exp_f32 v130, v130
    v_add_f32 v6, v6, v128
    v_fma_f32 v133, v133, s56, v8
    v_mfma_f32_16x16x32_bf16 v[72:75], v[240:243], v[180:183], v[72:75]
    v_exp_f32 v131, v131
    v_add_f32 v6, v6, v129
    v_fma_f32 v134, v134, s56, v8
    ds_read_b128 v[156:159], v18 offset:27648
    ds_read_b128 v[160:163], v18 offset:28672
    ds_read_b128 v[164:167], v18 offset:29696
    v_mfma_f32_16x16x32_bf16 v[80:83], v[240:243], v[184:187], v[80:83]
    v_exp_f32 v132, v132
    v_add_f32 v6, v6, v130
    v_fma_f32 v135, v135, s56, v8
    v_exp_f32 v133, v133
    v_mfma_f32_16x16x32_bf16 v[88:91], v[240:243], v[188:191], v[88:91]
    v_add_f32 v6, v6, v131
    v_exp_f32 v134, v134
    v_add_f32 v6, v6, v132
    s_waitcnt vmcnt(6)
    s_barrier
    v_mfma_f32_16x16x32_bf16 v[52:55], v[248:251], v[168:171], v[52:55]
    v_exp_f32 v135, v135
    v_add_f32 v6, v6, v133
    v_add_f32 v6, v6, v134
    ds_read_b64_tr_b16 v[240:241], v30 offset:32768
    ds_read_b64_tr_b16 v[242:243], v30 offset:49152
    v_mfma_f32_16x16x32_bf16 v[60:63], v[248:251], v[172:175], v[60:63]
    v_add_f32 v6, v6, v135
    v_cvt_pk_bf16_f32 v128, v128, v129
    v_cvt_pk_bf16_f32 v129, v130, v131
    ds_read_b64_tr_b16 v[244:245], v38 offset:32768
    ds_read_b64_tr_b16 v[246:247], v38 offset:49152
    v_mfma_f32_16x16x32_bf16 v[68:71], v[248:251], v[176:179], v[68:71]
    v_cvt_pk_bf16_f32 v130, v132, v133
    v_cvt_pk_bf16_f32 v131, v134, v135
    ds_write_b128 v39, v[128:131] offset:53248
    v_mfma_f32_16x16x32_bf16 v[76:79], v[248:251], v[180:183], v[76:79]
    v_fma_f32 v136, v136, s56, v9
    v_fma_f32 v137, v137, s56, v9
    v_fma_f32 v138, v138, s56, v9
    v_exp_f32 v136, v136
    v_mfma_f32_16x16x32_bf16 v[84:87], v[248:251], v[184:187], v[84:87]
    v_fma_f32 v139, v139, s56, v9
    v_exp_f32 v137, v137
    v_fma_f32 v140, v140, s56, v9
    v_mfma_f32_16x16x32_bf16 v[92:95], v[248:251], v[188:191], v[92:95]
    v_exp_f32 v138, v138
    v_add_f32 v7, v7, v136
    v_fma_f32 v141, v141, s56, v9
    s_waitcnt lgkmcnt(1)
    s_barrier
    v_mfma_f32_16x16x32_bf16 v[48:51], v[240:243], v[144:147], v[48:51]
    v_exp_f32 v139, v139
    v_add_f32 v7, v7, v137
    v_fma_f32 v142, v142, s56, v9
    v_mfma_f32_16x16x32_bf16 v[56:59], v[240:243], v[148:151], v[56:59]
    v_exp_f32 v140, v140
    v_add_f32 v7, v7, v138
    v_fma_f32 v143, v143, s56, v9
    v_exp_f32 v141, v141
    s_add_u32 m0, s45, 131072
    s_mov_b32 s53, 16384
    buffer_load_dwordx4 v28, s[20:23], s53 offen offset:0 nt lds
    buffer_load_dwordx4 v29, s[20:23], s53 offen offset:1024 nt lds
    ds_read_b128 v[168:171], v18 offset:30720
    ds_read_b128 v[172:175], v18 offset:31744
    ds_read_b128 v[176:179], v18 offset:32768
    v_mfma_f32_16x16x32_bf16 v[64:67], v[240:243], v[152:155], v[64:67]
    v_add_f32 v7, v7, v139
    v_exp_f32 v142, v142
    v_add_f32 v7, v7, v140
    v_mfma_f32_16x16x32_bf16 v[72:75], v[240:243], v[156:159], v[72:75]
    v_exp_f32 v143, v143
    v_add_f32 v7, v7, v141
    v_add_f32 v7, v7, v142
    ds_read_b128 v[180:183], v18 offset:33792
    ds_read_b128 v[184:187], v18 offset:34816
    ds_read_b128 v[188:191], v18 offset:35840
    v_mfma_f32_16x16x32_bf16 v[80:83], v[240:243], v[160:163], v[80:83]
    v_add_f32 v7, v7, v143
    v_cvt_pk_bf16_f32 v136, v136, v137
    v_cvt_pk_bf16_f32 v137, v138, v139
    v_mfma_f32_16x16x32_bf16 v[88:91], v[240:243], v[164:167], v[88:91]
    v_cvt_pk_bf16_f32 v138, v140, v141
    v_cvt_pk_bf16_f32 v139, v142, v143
    ds_write_b128 v39, v[136:139] offset:54272
    s_waitcnt vmcnt(6)
    s_barrier
    v_mfma_f32_16x16x32_bf16 v[52:55], v[244:247], v[144:147], v[52:55]
    ds_read_b64_tr_b16 v[240:241], v30 offset:34816
    ds_read_b64_tr_b16 v[242:243], v30 offset:51200
    v_mfma_f32_16x16x32_bf16 v[60:63], v[244:247], v[148:151], v[60:63]
    ds_read_b64_tr_b16 v[248:249], v38 offset:34816
    ds_read_b64_tr_b16 v[250:251], v38 offset:51200
    v_mfma_f32_16x16x32_bf16 v[68:71], v[244:247], v[152:155], v[68:71]
    v_mfma_f32_16x16x32_bf16 v[76:79], v[244:247], v[156:159], v[76:79]
    v_mfma_f32_16x16x32_bf16 v[84:87], v[244:247], v[160:163], v[84:87]
    v_mfma_f32_16x16x32_bf16 v[92:95], v[244:247], v[164:167], v[92:95]
    s_waitcnt lgkmcnt(0)
    s_barrier
    v_mfma_f32_16x16x32_bf16 v[48:51], v[240:243], v[168:171], v[48:51]
    v_mfma_f32_16x16x32_bf16 v[56:59], v[240:243], v[172:175], v[56:59]
    s_add_u32 m0, s45, 133120
    s_mov_b32 s53, 49152
    buffer_load_dwordx4 v28, s[20:23], s53 offen offset:0 nt lds
    buffer_load_dwordx4 v29, s[20:23], s53 offen offset:1024 nt lds
    ds_read_b128 v[144:147], v18 offset:36864
    ds_read_b128 v[148:151], v18 offset:37888
    ds_read_b128 v[152:155], v18 offset:38912
    v_mfma_f32_16x16x32_bf16 v[64:67], v[240:243], v[176:179], v[64:67]
    v_mfma_f32_16x16x32_bf16 v[72:75], v[240:243], v[180:183], v[72:75]
    ds_read_b128 v[156:159], v18 offset:39936
    ds_read_b128 v[160:163], v18 offset:40960
    ds_read_b128 v[164:167], v18 offset:41984
    v_mfma_f32_16x16x32_bf16 v[80:83], v[240:243], v[184:187], v[80:83]
    v_mfma_f32_16x16x32_bf16 v[88:91], v[240:243], v[188:191], v[88:91]
    s_waitcnt vmcnt(6)
    s_barrier
    v_mfma_f32_16x16x32_bf16 v[52:55], v[248:251], v[168:171], v[52:55]
    ds_read_b64_tr_b16 v[240:241], v30 offset:0
    ds_read_b64_tr_b16 v[242:243], v30 offset:16384
    v_mfma_f32_16x16x32_bf16 v[60:63], v[248:251], v[172:175], v[60:63]
    ds_read_b64_tr_b16 v[244:245], v38 offset:0
    ds_read_b64_tr_b16 v[246:247], v38 offset:16384
    v_mfma_f32_16x16x32_bf16 v[68:71], v[248:251], v[176:179], v[68:71]
    v_mfma_f32_16x16x32_bf16 v[76:79], v[248:251], v[180:183], v[76:79]
    v_mfma_f32_16x16x32_bf16 v[84:87], v[248:251], v[184:187], v[84:87]
    v_mfma_f32_16x16x32_bf16 v[92:95], v[248:251], v[188:191], v[92:95]
    s_waitcnt lgkmcnt(0)
    s_barrier
    v_mfma_f32_16x16x32_bf16 v[48:51], v[240:243], v[144:147], v[48:51]
    v_mfma_f32_16x16x32_bf16 v[56:59], v[240:243], v[148:151], v[56:59]
    s_add_u32 m0, s45, 98304
    s_mov_b32 s53, 81920
    buffer_load_dwordx4 v28, s[20:23], s53 offen offset:0 nt lds
    buffer_load_dwordx4 v29, s[20:23], s53 offen offset:1024 nt lds
    ds_read_b128 v[168:171], v18 offset:43008
    ds_read_b128 v[172:175], v18 offset:44032
    ds_read_b128 v[176:179], v18 offset:45056
    v_mfma_f32_16x16x32_bf16 v[64:67], v[240:243], v[152:155], v[64:67]
    v_mfma_f32_16x16x32_bf16 v[72:75], v[240:243], v[156:159], v[72:75]
    ds_read_b128 v[180:183], v18 offset:46080
    ds_read_b128 v[184:187], v18 offset:47104
    ds_read_b128 v[188:191], v18 offset:48128
    v_mfma_f32_16x16x32_bf16 v[80:83], v[240:243], v[160:163], v[80:83]
    v_mfma_f32_16x16x32_bf16 v[88:91], v[240:243], v[164:167], v[88:91]
    s_waitcnt vmcnt(6)
    s_barrier
    v_mfma_f32_16x16x32_bf16 v[52:55], v[244:247], v[144:147], v[52:55]
    ds_read_b64_tr_b16 v[240:241], v30 offset:2048
    ds_read_b64_tr_b16 v[242:243], v30 offset:18432
    v_mfma_f32_16x16x32_bf16 v[60:63], v[244:247], v[148:151], v[60:63]
    ds_read_b64_tr_b16 v[248:249], v38 offset:2048
    ds_read_b64_tr_b16 v[250:251], v38 offset:18432
    v_mfma_f32_16x16x32_bf16 v[68:71], v[244:247], v[152:155], v[68:71]
    ds_write_b128 v42, v[192:195] offset:0
    ds_write_b128 v42, v[196:199] offset:1024
    ds_write_b128 v42, v[200:203] offset:2048
    ds_write_b128 v42, v[204:207] offset:3072
    v_mfma_f32_16x16x32_bf16 v[76:79], v[244:247], v[156:159], v[76:79]
    ds_read_b64_tr_b16 v[192:193], v33 offset:0
    ds_read_b64_tr_b16 v[194:195], v33 offset:2048
    ds_read_b64_tr_b16 v[196:197], v34 offset:0
    ds_read_b64_tr_b16 v[198:199], v34 offset:2048
    v_mfma_f32_16x16x32_bf16 v[84:87], v[244:247], v[160:163], v[84:87]
    ds_read_b64_tr_b16 v[200:201], v35 offset:0
    ds_read_b64_tr_b16 v[202:203], v35 offset:2048
    ds_read_b64_tr_b16 v[204:205], v36 offset:0
    ds_read_b64_tr_b16 v[206:207], v36 offset:2048
    v_mfma_f32_16x16x32_bf16 v[92:95], v[244:247], v[164:167], v[92:95]
    s_waitcnt lgkmcnt(12)
    s_barrier
    v_mfma_f32_16x16x32_bf16 v[48:51], v[240:243], v[168:171], v[48:51]
    v_mfma_f32_16x16x32_bf16 v[56:59], v[240:243], v[172:175], v[56:59]
    s_add_u32 m0, s45, 100352
    s_mov_b32 s53, 114688
    buffer_load_dwordx4 v28, s[20:23], s53 offen offset:0 nt lds
    buffer_load_dwordx4 v29, s[20:23], s53 offen offset:1024 nt lds
    ds_read_b128 v[144:147], v18 offset:49152
    ds_read_b128 v[148:151], v18 offset:50176
    ds_read_b128 v[152:155], v18 offset:51200
    v_mfma_f32_16x16x32_bf16 v[64:67], v[240:243], v[176:179], v[64:67]
    v_mfma_f32_16x16x32_bf16 v[72:75], v[240:243], v[180:183], v[72:75]
    ds_read_b128 v[156:159], v18 offset:52224
    ds_read_b128 v[160:163], v18 offset:53248
    ds_read_b128 v[164:167], v18 offset:54272
    v_mfma_f32_16x16x32_bf16 v[80:83], v[240:243], v[184:187], v[80:83]
    v_mfma_f32_16x16x32_bf16 v[88:91], v[240:243], v[188:191], v[88:91]
    s_waitcnt vmcnt(6)
    s_barrier
    v_mfma_f32_16x16x32_bf16 v[52:55], v[248:251], v[168:171], v[52:55]
    ds_read_b64_tr_b16 v[240:241], v30 offset:32768
    ds_read_b64_tr_b16 v[242:243], v30 offset:49152
    v_mfma_f32_16x16x32_bf16 v[60:63], v[248:251], v[172:175], v[60:63]
    ds_read_b64_tr_b16 v[244:245], v38 offset:32768
    ds_read_b64_tr_b16 v[246:247], v38 offset:49152
    v_mfma_f32_16x16x32_bf16 v[68:71], v[248:251], v[176:179], v[68:71]
    s_nop 1
    v_permlane32_swap_b32 v1, v3
    v_permlane32_swap_b32 v4, v5
    v_permlane32_swap_b32 v6, v7
    s_nop 1
    v_add_f32 v1, v1, v3
    v_add_f32 v4, v4, v5
    v_add_f32 v6, v6, v7
    v_mov_b32 v43, v6
    s_nop 1
    v_permlane16_swap_b32 v1, v4
    v_permlane16_swap_b32 v6, v43
    s_nop 1
    v_add_f32 v1, v1, v4
    v_add_f32 v6, v6, v43
    v_mfma_f32_16x16x32_bf16 v[76:79], v[248:251], v[180:183], v[76:79]
    v_mfma_f32_16x16x32_bf16 v[84:87], v[248:251], v[184:187], v[84:87]
    v_mfma_f32_16x16x32_bf16 v[92:95], v[248:251], v[188:191], v[92:95]
    s_waitcnt lgkmcnt(0)
    s_barrier
    v_mfma_f32_16x16x32_bf16 v[48:51], v[240:243], v[144:147], v[48:51]
    v_mfma_f32_16x16x32_bf16 v[56:59], v[240:243], v[148:151], v[56:59]
    s_add_u32 m0, s45, 131072
    s_mov_b32 s53, 147456
    buffer_load_dwordx4 v28, s[20:23], s53 offen offset:0 nt lds
    buffer_load_dwordx4 v29, s[20:23], s53 offen offset:1024 nt lds
    ds_read_b128 v[168:171], v18 offset:55296
    ds_read_b128 v[172:175], v18 offset:56320
    ds_read_b128 v[176:179], v18 offset:57344
    v_mfma_f32_16x16x32_bf16 v[64:67], v[240:243], v[152:155], v[64:67]
    v_mfma_f32_16x16x32_bf16 v[72:75], v[240:243], v[156:159], v[72:75]
    ds_read_b128 v[180:183], v18 offset:58368
    ds_read_b128 v[184:187], v18 offset:59392
    ds_read_b128 v[188:191], v18 offset:60416
    v_mfma_f32_16x16x32_bf16 v[80:83], v[240:243], v[160:163], v[80:83]
    v_mfma_f32_16x16x32_bf16 v[88:91], v[240:243], v[164:167], v[88:91]
    s_waitcnt vmcnt(6)
    s_barrier
    v_mfma_f32_16x16x32_bf16 v[52:55], v[244:247], v[144:147], v[52:55]
    ds_read_b64_tr_b16 v[240:241], v30 offset:34816
    ds_read_b64_tr_b16 v[242:243], v30 offset:51200
    v_mfma_f32_16x16x32_bf16 v[60:63], v[244:247], v[148:151], v[60:63]
    ds_read_b64_tr_b16 v[248:249], v38 offset:34816
    ds_read_b64_tr_b16 v[250:251], v38 offset:51200
    v_mfma_f32_16x16x32_bf16 v[68:71], v[244:247], v[152:155], v[68:71]
    ds_write_b32 v27, v1
    v_mfma_f32_16x16x32_bf16 v[76:79], v[244:247], v[156:159], v[76:79]
    ds_write_b32 v37, v6
    v_mfma_f32_16x16x32_bf16 v[84:87], v[244:247], v[160:163], v[84:87]
    v_mfma_f32_16x16x32_bf16 v[92:95], v[244:247], v[164:167], v[92:95]
    s_waitcnt lgkmcnt(2)
    s_barrier
    v_mfma_f32_16x16x32_bf16 v[48:51], v[240:243], v[168:171], v[48:51]
    v_mfma_f32_16x16x32_bf16 v[56:59], v[240:243], v[172:175], v[56:59]
    s_add_u32 m0, s45, 133120
    s_mov_b32 s53, 180224
    buffer_load_dwordx4 v28, s[20:23], s53 offen offset:0 nt lds
    buffer_load_dwordx4 v29, s[20:23], s53 offen offset:1024 nt lds
    ds_read_b128 v[144:147], v18 offset:61440
    ds_read_b128 v[148:151], v18 offset:62464
    ds_read_b128 v[152:155], v18 offset:63488
    v_mfma_f32_16x16x32_bf16 v[64:67], v[240:243], v[176:179], v[64:67]
    v_mfma_f32_16x16x32_bf16 v[72:75], v[240:243], v[180:183], v[72:75]
    ds_read_b128 v[156:159], v18 offset:64512
    ds_read_b128 v[160:163], v19 offset:0
    ds_read_b128 v[164:167], v19 offset:1024
    v_mfma_f32_16x16x32_bf16 v[80:83], v[240:243], v[184:187], v[80:83]
    v_mfma_f32_16x16x32_bf16 v[88:91], v[240:243], v[188:191], v[88:91]
    s_waitcnt vmcnt(6)
    s_barrier
    v_mfma_f32_16x16x32_bf16 v[52:55], v[248:251], v[168:171], v[52:55]
    ds_read_b64_tr_b16 v[240:241], v30 offset:0
    ds_read_b64_tr_b16 v[242:243], v30 offset:16384
    v_mfma_f32_16x16x32_bf16 v[60:63], v[248:251], v[172:175], v[60:63]
    ds_read_b64_tr_b16 v[244:245], v38 offset:0
    ds_read_b64_tr_b16 v[246:247], v38 offset:16384
    v_mfma_f32_16x16x32_bf16 v[68:71], v[248:251], v[176:179], v[68:71]
    ds_write_b128 v42, v[208:211] offset:0
    ds_write_b128 v42, v[212:215] offset:1024
    ds_write_b128 v42, v[216:219] offset:2048
    ds_write_b128 v42, v[220:223] offset:3072
    v_mfma_f32_16x16x32_bf16 v[76:79], v[248:251], v[180:183], v[76:79]
    ds_read_b64_tr_b16 v[208:209], v33 offset:0
    ds_read_b64_tr_b16 v[210:211], v33 offset:2048
    ds_read_b64_tr_b16 v[212:213], v34 offset:0
    ds_read_b64_tr_b16 v[214:215], v34 offset:2048
    v_mfma_f32_16x16x32_bf16 v[84:87], v[248:251], v[184:187], v[84:87]
    ds_read_b64_tr_b16 v[216:217], v35 offset:0
    ds_read_b64_tr_b16 v[218:219], v35 offset:2048
    ds_read_b64_tr_b16 v[220:221], v36 offset:0
    ds_read_b64_tr_b16 v[222:223], v36 offset:2048
    v_mfma_f32_16x16x32_bf16 v[92:95], v[248:251], v[188:191], v[92:95]
    s_waitcnt lgkmcnt(12)
    s_barrier
    v_mfma_f32_16x16x32_bf16 v[48:51], v[240:243], v[144:147], v[48:51]
    v_mfma_f32_16x16x32_bf16 v[56:59], v[240:243], v[148:151], v[56:59]
    s_add_u32 m0, s45, 98304
    s_mov_b32 s53, 212992
    buffer_load_dwordx4 v28, s[20:23], s53 offen offset:0 nt lds
    buffer_load_dwordx4 v29, s[20:23], s53 offen offset:1024 nt lds
    ds_read_b128 v[168:171], v19 offset:2048
    ds_read_b128 v[172:175], v19 offset:3072
    ds_read_b128 v[176:179], v19 offset:4096
    v_mfma_f32_16x16x32_bf16 v[64:67], v[240:243], v[152:155], v[64:67]
    v_mfma_f32_16x16x32_bf16 v[72:75], v[240:243], v[156:159], v[72:75]
    ds_read_b128 v[180:183], v19 offset:5120
    ds_read_b128 v[184:187], v19 offset:6144
    ds_read_b128 v[188:191], v19 offset:7168
    v_mfma_f32_16x16x32_bf16 v[80:83], v[240:243], v[160:163], v[80:83]
    v_mfma_f32_16x16x32_bf16 v[88:91], v[240:243], v[164:167], v[88:91]
    s_waitcnt vmcnt(6)
    s_barrier
    v_mfma_f32_16x16x32_bf16 v[52:55], v[244:247], v[144:147], v[52:55]
    ds_read_b64_tr_b16 v[240:241], v30 offset:2048
    ds_read_b64_tr_b16 v[242:243], v30 offset:18432
    v_mfma_f32_16x16x32_bf16 v[60:63], v[244:247], v[148:151], v[60:63]
    ds_read_b64_tr_b16 v[248:249], v38 offset:2048
    ds_read_b64_tr_b16 v[250:251], v38 offset:18432
    v_mfma_f32_16x16x32_bf16 v[68:71], v[244:247], v[152:155], v[68:71]
    ds_read_b128 v[12:15], v25
    v_mfma_f32_16x16x32_bf16 v[76:79], v[244:247], v[156:159], v[76:79]
    ds_read_b128 v[20:23], v25 offset:16
    v_mfma_f32_16x16x32_bf16 v[84:87], v[244:247], v[160:163], v[84:87]
    v_mfma_f32_16x16x32_bf16 v[92:95], v[244:247], v[164:167], v[92:95]
    s_waitcnt lgkmcnt(2)
    s_barrier
    v_mfma_f32_16x16x32_bf16 v[48:51], v[240:243], v[168:171], v[48:51]
    v_mfma_f32_16x16x32_bf16 v[56:59], v[240:243], v[172:175], v[56:59]
    s_add_u32 m0, s45, 100352
    s_mov_b32 s53, 245760
    buffer_load_dwordx4 v28, s[20:23], s53 offen offset:0 nt lds
    buffer_load_dwordx4 v29, s[20:23], s53 offen offset:1024 nt lds
    ds_read_b128 v[144:147], v19 offset:8192
    ds_read_b128 v[148:151], v19 offset:9216
    ds_read_b128 v[152:155], v19 offset:10240
    v_mfma_f32_16x16x32_bf16 v[64:67], v[240:243], v[176:179], v[64:67]
    v_mfma_f32_16x16x32_bf16 v[72:75], v[240:243], v[180:183], v[72:75]
    ds_read_b128 v[156:159], v19 offset:11264
    ds_read_b128 v[160:163], v19 offset:12288
    ds_read_b128 v[164:167], v19 offset:13312
    s_waitcnt lgkmcnt(6)
    v_add_f32 v12, v12, v13
    v_add_f32 v14, v14, v15
    v_add_f32 v20, v20, v21
    v_add_f32 v22, v22, v23
    v_add_f32 v12, v12, v14
    v_add_f32 v20, v20, v22
    v_add_f32 v12, v12, v20
    v_rcp_f32 v44, v12
    v_mfma_f32_16x16x32_bf16 v[80:83], v[240:243], v[184:187], v[80:83]
    v_mfma_f32_16x16x32_bf16 v[88:91], v[240:243], v[188:191], v[88:91]
    s_waitcnt vmcnt(6)
    s_barrier
    v_mfma_f32_16x16x32_bf16 v[52:55], v[248:251], v[168:171], v[52:55]
    ds_read_b64_tr_b16 v[240:241], v30 offset:32768
    ds_read_b64_tr_b16 v[242:243], v30 offset:49152
    v_mfma_f32_16x16x32_bf16 v[60:63], v[248:251], v[172:175], v[60:63]
    ds_read_b64_tr_b16 v[244:245], v38 offset:32768
    ds_read_b64_tr_b16 v[246:247], v38 offset:49152
    v_mfma_f32_16x16x32_bf16 v[68:71], v[248:251], v[176:179], v[68:71]
    ds_write_b128 v42, v[224:227] offset:0
    ds_write_b128 v42, v[228:231] offset:1024
    ds_write_b128 v42, v[232:235] offset:2048
    ds_write_b128 v42, v[236:239] offset:3072
    v_mfma_f32_16x16x32_bf16 v[76:79], v[248:251], v[180:183], v[76:79]
    ds_read_b64_tr_b16 v[224:225], v33 offset:0
    ds_read_b64_tr_b16 v[226:227], v33 offset:2048
    ds_read_b64_tr_b16 v[228:229], v34 offset:0
    ds_read_b64_tr_b16 v[230:231], v34 offset:2048
    v_mfma_f32_16x16x32_bf16 v[84:87], v[248:251], v[184:187], v[84:87]
    ds_read_b64_tr_b16 v[232:233], v35 offset:0
    ds_read_b64_tr_b16 v[234:235], v35 offset:2048
    ds_read_b64_tr_b16 v[236:237], v36 offset:0
    ds_read_b64_tr_b16 v[238:239], v36 offset:2048
    v_mfma_f32_16x16x32_bf16 v[92:95], v[248:251], v[188:191], v[92:95]
    s_waitcnt lgkmcnt(12)
    s_barrier
    v_mfma_f32_16x16x32_bf16 v[48:51], v[240:243], v[144:147], v[48:51]
    v_mfma_f32_16x16x32_bf16 v[56:59], v[240:243], v[148:151], v[56:59]
    s_add_u32 m0, s45, 131072
    s_add_u32 s53, s59, 12
    s_and_b32 s53, s53, 15
    s_mul_i32 s53, s53, 14336
    buffer_load_dwordx4 v31, s[24:27], s53 offen offset:0 lds
    buffer_load_dwordx4 v32, s[24:27], s53 offen offset:1024 lds
    ds_read_b128 v[168:171], v19 offset:14336
    ds_read_b128 v[172:175], v19 offset:15360
    ds_read_b128 v[176:179], v19 offset:16384
    v_mfma_f32_16x16x32_bf16 v[64:67], v[240:243], v[152:155], v[64:67]
    v_mfma_f32_16x16x32_bf16 v[72:75], v[240:243], v[156:159], v[72:75]
    ds_read_b128 v[180:183], v19 offset:17408
    ds_read_b128 v[184:187], v19 offset:18432
    ds_read_b128 v[188:191], v19 offset:19456
    v_mfma_f32_16x16x32_bf16 v[80:83], v[240:243], v[160:163], v[80:83]
    v_mfma_f32_16x16x32_bf16 v[88:91], v[240:243], v[164:167], v[88:91]
    s_waitcnt vmcnt(6)
    s_barrier
    v_mfma_f32_16x16x32_bf16 v[52:55], v[244:247], v[144:147], v[52:55]
    ds_read_b64_tr_b16 v[240:241], v30 offset:34816
    ds_read_b64_tr_b16 v[242:243], v30 offset:51200
    v_mfma_f32_16x16x32_bf16 v[60:63], v[244:247], v[148:151], v[60:63]
    ds_read_b64_tr_b16 v[248:249], v38 offset:34816
    ds_read_b64_tr_b16 v[250:251], v38 offset:51200
    v_mfma_f32_16x16x32_bf16 v[68:71], v[244:247], v[152:155], v[68:71]
    ds_read_b128 v[12:15], v26
    v_mfma_f32_16x16x32_bf16 v[76:79], v[244:247], v[156:159], v[76:79]
    ds_read_b128 v[20:23], v26 offset:16
    v_mfma_f32_16x16x32_bf16 v[84:87], v[244:247], v[160:163], v[84:87]
    v_mfma_f32_16x16x32_bf16 v[92:95], v[244:247], v[164:167], v[92:95]
    s_waitcnt lgkmcnt(2)
    s_barrier
    v_mfma_f32_16x16x32_bf16 v[48:51], v[240:243], v[168:171], v[48:51]
    v_mfma_f32_16x16x32_bf16 v[56:59], v[240:243], v[172:175], v[56:59]
    s_add_u32 m0, s45, 133120
    s_add_u32 s53, s59, 13
    s_and_b32 s53, s53, 15
    s_mul_i32 s53, s53, 14336
    buffer_load_dwordx4 v31, s[24:27], s53 offen offset:0 lds
    buffer_load_dwordx4 v32, s[24:27], s53 offen offset:1024 lds
    ds_read_b128 v[144:147], v19 offset:20480
    ds_read_b128 v[148:151], v19 offset:21504
    ds_read_b128 v[152:155], v19 offset:22528
    v_mfma_f32_16x16x32_bf16 v[64:67], v[240:243], v[176:179], v[64:67]
    v_mfma_f32_16x16x32_bf16 v[72:75], v[240:243], v[180:183], v[72:75]
    s_add_u32 m0, s45, 0
    s_add_u32 s53, s59, 6
    s_and_b32 s53, s53, 15
    s_mul_i32 s53, s53, 14336
    buffer_load_dwordx4 v31, s[24:27], s53 offen offset:0 lds
    buffer_load_dwordx4 v32, s[24:27], s53 offen offset:1024 lds
    ds_read_b128 v[156:159], v19 offset:23552
    ds_read_b128 v[160:163], v19 offset:24576
    ds_read_b128 v[164:167], v19 offset:25600
    s_waitcnt lgkmcnt(6)
    v_add_f32 v12, v12, v13
    v_add_f32 v14, v14, v15
    v_add_f32 v20, v20, v21
    v_add_f32 v22, v22, v23
    v_add_f32 v12, v12, v14
    v_add_f32 v20, v20, v22
    v_add_f32 v12, v12, v20
    v_rcp_f32 v8, v12
    v_mfma_f32_16x16x32_bf16 v[80:83], v[240:243], v[184:187], v[80:83]
    v_mfma_f32_16x16x32_bf16 v[88:91], v[240:243], v[188:191], v[88:91]
    s_waitcnt vmcnt(8)
    s_barrier
    v_mfma_f32_16x16x32_bf16 v[52:55], v[248:251], v[168:171], v[52:55]
    ds_read_b64_tr_b16 v[240:241], v30 offset:0
    ds_read_b64_tr_b16 v[242:243], v30 offset:16384
    v_mfma_f32_16x16x32_bf16 v[60:63], v[248:251], v[172:175], v[60:63]
    ds_read_b64_tr_b16 v[244:245], v38 offset:0
    ds_read_b64_tr_b16 v[246:247], v38 offset:16384
    v_mfma_f32_16x16x32_bf16 v[68:71], v[248:251], v[176:179], v[68:71]
    v_mfma_f32_16x16x32_bf16 v[76:79], v[248:251], v[180:183], v[76:79]
    v_mfma_f32_16x16x32_bf16 v[84:87], v[248:251], v[184:187], v[84:87]
    v_mfma_f32_16x16x32_bf16 v[92:95], v[248:251], v[188:191], v[92:95]
    s_waitcnt lgkmcnt(0)
    s_barrier
    v_mfma_f32_16x16x32_bf16 v[48:51], v[240:243], v[144:147], v[48:51]
    v_mfma_f32_16x16x32_bf16 v[56:59], v[240:243], v[148:151], v[56:59]
    s_add_u32 m0, s45, 98304
    s_add_u32 s53, s59, 14
    s_and_b32 s53, s53, 15
    s_mul_i32 s53, s53, 14336
    buffer_load_dwordx4 v31, s[24:27], s53 offen offset:0 lds
    buffer_load_dwordx4 v32, s[24:27], s53 offen offset:1024 lds
    ds_read_b128 v[168:171], v19 offset:26624
    ds_read_b128 v[172:175], v19 offset:27648
    ds_read_b128 v[176:179], v19 offset:28672
    v_mfma_f32_16x16x32_bf16 v[64:67], v[240:243], v[152:155], v[64:67]
    v_mfma_f32_16x16x32_bf16 v[72:75], v[240:243], v[156:159], v[72:75]
    s_add_u32 m0, s45, 2048
    s_add_u32 s53, s59, 7
    s_and_b32 s53, s53, 15
    s_mul_i32 s53, s53, 14336
    buffer_load_dwordx4 v31, s[24:27], s53 offen offset:0 lds
    buffer_load_dwordx4 v32, s[24:27], s53 offen offset:1024 lds
    ds_read_b128 v[180:183], v19 offset:29696
    ds_read_b128 v[184:187], v19 offset:30720
    ds_read_b128 v[188:191], v19 offset:31744
    v_mov_b32 v46, v44
    v_mov_b32 v9, v8
    s_nop 1
    v_permlane16_swap_b32 v44, v46
    v_permlane32_swap_b32 v8, v9
    s_nop 1
    v_mov_b32 v45, v44
    v_mov_b32 v47, v46
    s_nop 1
    v_permlane32_swap_b32 v44, v45
    v_permlane32_swap_b32 v46, v47
    s_nop 1
    v_mfma_f32_16x16x32_bf16 v[80:83], v[240:243], v[160:163], v[80:83]
    v_mfma_f32_16x16x32_bf16 v[88:91], v[240:243], v[164:167], v[88:91]
    s_waitcnt vmcnt(10)
    s_barrier
    v_mfma_f32_16x16x32_bf16 v[52:55], v[244:247], v[144:147], v[52:55]
    ds_read_b64_tr_b16 v[240:241], v30 offset:2048
    ds_read_b64_tr_b16 v[242:243], v30 offset:18432
    v_mfma_f32_16x16x32_bf16 v[60:63], v[244:247], v[148:151], v[60:63]
    ds_read_b64_tr_b16 v[248:249], v38 offset:2048
    ds_read_b64_tr_b16 v[250:251], v38 offset:18432
    v_mfma_f32_16x16x32_bf16 v[68:71], v[244:247], v[152:155], v[68:71]
    v_mfma_f32_16x16x32_bf16 v[76:79], v[244:247], v[156:159], v[76:79]
    v_mfma_f32_16x16x32_bf16 v[84:87], v[244:247], v[160:163], v[84:87]
    v_mfma_f32_16x16x32_bf16 v[92:95], v[244:247], v[164:167], v[92:95]
    s_waitcnt lgkmcnt(0)
    s_barrier
    v_mfma_f32_16x16x32_bf16 v[48:51], v[240:243], v[168:171], v[48:51]
    v_mfma_f32_16x16x32_bf16 v[56:59], v[240:243], v[172:175], v[56:59]
    s_add_u32 m0, s45, 100352
    s_add_u32 s53, s59, 15
    s_and_b32 s53, s53, 15
    s_mul_i32 s53, s53, 14336
    buffer_load_dwordx4 v31, s[24:27], s53 offen offset:0 lds
    buffer_load_dwordx4 v32, s[24:27], s53 offen offset:1024 lds
    v_mfma_f32_16x16x32_bf16 v[64:67], v[240:243], v[176:179], v[64:67]
    v_mfma_f32_16x16x32_bf16 v[72:75], v[240:243], v[180:183], v[72:75]
    s_add_u32 s53, s59, 8
    s_and_b32 s53, s53, 15
    s_mul_i32 s53, s53, 14336
    buffer_load_dwordx4 v[112:115], v31, s[24:27], s53 offen offset:0
    buffer_load_dwordx4 v[116:119], v32, s[24:27], s53 offen offset:1024
    s_add_u32 s53, s59, 9
    s_and_b32 s53, s53, 15
    s_mul_i32 s53, s53, 14336
    buffer_load_dwordx4 v[120:123], v31, s[24:27], s53 offen offset:0
    buffer_load_dwordx4 v[124:127], v32, s[24:27], s53 offen offset:1024
    v_mfma_f32_16x16x32_bf16 v[80:83], v[240:243], v[184:187], v[80:83]
    v_mfma_f32_16x16x32_bf16 v[88:91], v[240:243], v[188:191], v[88:91]
    v_mfma_f32_16x16x32_bf16 v[52:55], v[248:251], v[168:171], v[52:55]
    v_mfma_f32_16x16x32_bf16 v[60:63], v[248:251], v[172:175], v[60:63]
    v_mfma_f32_16x16x32_bf16 v[68:71], v[248:251], v[176:179], v[68:71]
    v_mfma_f32_16x16x32_bf16 v[76:79], v[248:251], v[180:183], v[76:79]
    v_mfma_f32_16x16x32_bf16 v[84:87], v[248:251], v[184:187], v[84:87]
    v_mfma_f32_16x16x32_bf16 v[92:95], v[248:251], v[188:191], v[92:95]
    s_lshr_b32 s3, s59, 1
    s_sub_u32 s3, s4, s3
    s_and_b32 s3, s3, 7
    s_mul_i32 s3, s3, 6144
    s_add_u32 s3, s3, 49152
    v_add_u32 v39, s3, v18
    s_mul_i32 s56, s7, 86016
    s_mul_i32 s3, s4, 12288
    s_add_u32 s56, s56, s3
    v_mov_b32 v12, 32768
    v_mov_b32 v14, 0
    v_mov_b32 v15, 0
    ds_write_b64 v12, v[14:15]
    v_cvt_pk_bf16_f32 v48, v48, v49
    v_cvt_pk_bf16_f32 v49, v50, v51
    v_cvt_pk_bf16_f32 v50, v52, v53
    v_cvt_pk_bf16_f32 v51, v54, v55
    ds_write_b128 v39, v[48:51] offset:0
    v_cvt_pk_bf16_f32 v56, v56, v57
    v_cvt_pk_bf16_f32 v57, v58, v59
    v_cvt_pk_bf16_f32 v58, v60, v61
    v_cvt_pk_bf16_f32 v59, v62, v63
    ds_write_b128 v39, v[56:59] offset:1024
    v_cvt_pk_bf16_f32 v64, v64, v65
    v_cvt_pk_bf16_f32 v65, v66, v67
    v_cvt_pk_bf16_f32 v66, v68, v69
    v_cvt_pk_bf16_f32 v67, v70, v71
    ds_write_b128 v39, v[64:67] offset:2048
    v_cvt_pk_bf16_f32 v72, v72, v73
    v_cvt_pk_bf16_f32 v73, v74, v75
    v_cvt_pk_bf16_f32 v74, v76, v77
    v_cvt_pk_bf16_f32 v75, v78, v79
    ds_write_b128 v39, v[72:75] offset:3072
    v_cvt_pk_bf16_f32 v80, v80, v81
    v_cvt_pk_bf16_f32 v81, v82, v83
    v_cvt_pk_bf16_f32 v82, v84, v85
    v_cvt_pk_bf16_f32 v83, v86, v87
    ds_write_b128 v39, v[80:83] offset:4096
    v_cvt_pk_bf16_f32 v88, v88, v89
    v_cvt_pk_bf16_f32 v89, v90, v91
    v_cvt_pk_bf16_f32 v90, v92, v93
    v_cvt_pk_bf16_f32 v91, v94, v95
    ds_write_b128 v39, v[88:91] offset:5120
    v_add_u32 v20, 98304, v33
    v_add_u32 v21, 98304, v34
    v_add_u32 v22, 98304, v35
    v_add_u32 v23, 98304, v36
    v_add_u32 v39, 49152, v18
    s_waitcnt lgkmcnt(0)
    s_barrier
    s_cmp_eq_u32 s4, 7
    s_cbranch_scc1 L_w7
    s_cmp_ge_u32 s4, 4
    s_cbranch_scc1 L_noprio
    s_setprio 1
L_noprio:
    ds_read_b128 v[240:243], v39 offset:0
    ds_read_b128 v[244:247], v39 offset:1024
    ds_read_b128 v[248:251], v39 offset:6144
    s_waitcnt lgkmcnt(2)
    v_mfma_f32_16x16x32_bf16 v[48:51], v[192:195], v[240:243], 0
    ds_read_b128 v[252:255], v39 offset:7168
    v_mfma_f32_16x16x32_bf16 v[52:55], v[196:199], v[240:243], 0
    s_add_u32 s53, s59, 10
    s_and_b32 s53, s53, 15
    s_mul_i32 s53, s53, 14336
    buffer_load_dwordx4 v[128:131], v31, s[24:27], s53 offen offset:0
    v_mfma_f32_16x16x32_bf16 v[56:59], v[200:203], v[240:243], 0
    v_mfma_f32_16x16x32_bf16 v[60:63], v[204:207], v[240:243], 0
    s_add_u32 s53, s59, 10
    s_and_b32 s53, s53, 15
    s_mul_i32 s53, s53, 14336
    buffer_load_dwordx4 v[132:135], v32, s[24:27], s53 offen offset:1024
    s_waitcnt lgkmcnt(2)
    v_mfma_f32_16x16x32_bf16 v[64:67], v[192:195], v[244:247], 0
    ds_read_b128 v[240:243], v39 offset:12288
    v_mfma_f32_16x16x32_bf16 v[68:71], v[196:199], v[244:247], 0
    s_add_u32 s53, s59, 11
    s_and_b32 s53, s53, 15
    s_mul_i32 s53, s53, 14336
    buffer_load_dwordx4 v[136:139], v31, s[24:27], s53 offen offset:0
    v_mfma_f32_16x16x32_bf16 v[72:75], v[200:203], v[244:247], 0
    v_mfma_f32_16x16x32_bf16 v[76:79], v[204:207], v[244:247], 0
    s_add_u32 s53, s59, 11
    s_and_b32 s53, s53, 15
    s_mul_i32 s53, s53, 14336
    buffer_load_dwordx4 v[140:143], v32, s[24:27], s53 offen offset:1024
    s_waitcnt lgkmcnt(2)
    v_mfma_f32_16x16x32_bf16 v[48:51], v[208:211], v[248:251], v[48:51]
    ds_read_b128 v[244:247], v39 offset:13312
    s_waitcnt vmcnt(16)
    ds_read_b64_tr_b16 v[160:161], v20 offset:32768
    v_mfma_f32_16x16x32_bf16 v[52:55], v[212:215], v[248:251], v[52:55]
    ds_read_b64_tr_b16 v[162:163], v20 offset:34816
    ds_read_b64_tr_b16 v[164:165], v21 offset:32768
    v_mfma_f32_16x16x32_bf16 v[56:59], v[216:219], v[248:251], v[56:59]
    ds_read_b64_tr_b16 v[166:167], v21 offset:34816
    ds_read_b64_tr_b16 v[168:169], v22 offset:32768
    v_mfma_f32_16x16x32_bf16 v[60:63], v[220:223], v[248:251], v[60:63]
    ds_read_b64_tr_b16 v[170:171], v22 offset:34816
    ds_read_b64_tr_b16 v[172:173], v23 offset:32768
    s_waitcnt lgkmcnt(9)
    v_mfma_f32_16x16x32_bf16 v[64:67], v[208:211], v[252:255], v[64:67]
    ds_read_b128 v[248:251], v39 offset:36864
    ds_read_b64_tr_b16 v[174:175], v23 offset:34816
    v_mfma_f32_16x16x32_bf16 v[68:71], v[212:215], v[252:255], v[68:71]
    v_mfma_f32_16x16x32_bf16 v[72:75], v[216:219], v[252:255], v[72:75]
    v_mfma_f32_16x16x32_bf16 v[76:79], v[220:223], v[252:255], v[76:79]
    s_waitcnt lgkmcnt(10)
    v_mfma_f32_16x16x32_bf16 v[48:51], v[224:227], v[240:243], v[48:51]
    ds_read_b128 v[252:255], v39 offset:37888
    s_waitcnt vmcnt(10)
    ds_read_b64_tr_b16 v[96:97], v33 offset:0
    v_mfma_f32_16x16x32_bf16 v[52:55], v[228:231], v[240:243], v[52:55]
    ds_read_b64_tr_b16 v[98:99], v33 offset:2048
    ds_read_b64_tr_b16 v[100:101], v34 offset:0
    v_mfma_f32_16x16x32_bf16 v[56:59], v[232:235], v[240:243], v[56:59]
    ds_read_b64_tr_b16 v[102:103], v34 offset:2048
    ds_read_b64_tr_b16 v[104:105], v35 offset:0
    v_mfma_f32_16x16x32_bf16 v[60:63], v[236:239], v[240:243], v[60:63]
    ds_read_b64_tr_b16 v[106:107], v35 offset:2048
    ds_read_b64_tr_b16 v[108:109], v36 offset:0
    s_waitcnt lgkmcnt(14)
    v_mfma_f32_16x16x32_bf16 v[64:67], v[224:227], v[244:247], v[64:67]
    ds_read_b128 v[240:243], v39 offset:18432
    ds_read_b64_tr_b16 v[110:111], v36 offset:2048
    v_mfma_f32_16x16x32_bf16 v[68:71], v[228:231], v[244:247], v[68:71]
    v_mfma_f32_16x16x32_bf16 v[72:75], v[232:235], v[244:247], v[72:75]
    v_mfma_f32_16x16x32_bf16 v[76:79], v[236:239], v[244:247], v[76:79]
    s_waitcnt lgkmcnt(10)
    v_mfma_f32_16x16x32_bf16 v[48:51], v[160:163], v[248:251], v[48:51]
    ds_read_b128 v[244:247], v39 offset:19456
    s_waitcnt vmcnt(8)
    ds_read_b64_tr_b16 v[176:177], v20 offset:0
    v_mfma_f32_16x16x32_bf16 v[52:55], v[164:167], v[248:251], v[52:55]
    ds_read_b64_tr_b16 v[178:179], v20 offset:2048
    ds_read_b64_tr_b16 v[180:181], v21 offset:0
    v_mfma_f32_16x16x32_bf16 v[56:59], v[168:171], v[248:251], v[56:59]
    ds_read_b64_tr_b16 v[182:183], v21 offset:2048
    ds_read_b64_tr_b16 v[184:185], v22 offset:0
    v_mfma_f32_16x16x32_bf16 v[60:63], v[172:175], v[248:251], v[60:63]
    ds_read_b64_tr_b16 v[186:187], v22 offset:2048
    ds_read_b64_tr_b16 v[188:189], v23 offset:0
    s_waitcnt lgkmcnt(14)
    v_mfma_f32_16x16x32_bf16 v[64:67], v[160:163], v[252:255], v[64:67]
    ds_read_b128 v[248:251], v39 offset:43008
    ds_read_b64_tr_b16 v[190:191], v23 offset:2048
    v_mfma_f32_16x16x32_bf16 v[68:71], v[164:167], v[252:255], v[68:71]
    v_mfma_f32_16x16x32_bf16 v[72:75], v[168:171], v[252:255], v[72:75]
    v_mfma_f32_16x16x32_bf16 v[76:79], v[172:175], v[252:255], v[76:79]
    s_waitcnt lgkmcnt(10)
    v_mfma_f32_16x16x32_bf16 v[48:51], v[96:99], v[240:243], v[48:51]
    ds_read_b128 v[252:255], v39 offset:44032
    s_waitcnt vmcnt(4)
    ds_write_b128 v42, v[112:115] offset:0
    v_mfma_f32_16x16x32_bf16 v[52:55], v[100:103], v[240:243], v[52:55]
    ds_write_b128 v42, v[116:119] offset:1024
    ds_write_b128 v42, v[120:123] offset:2048
    v_mfma_f32_16x16x32_bf16 v[56:59], v[104:107], v[240:243], v[56:59]
    ds_write_b128 v42, v[124:127] offset:3072
    ds_read_b64_tr_b16 v[112:113], v33 offset:0
    v_mfma_f32_16x16x32_bf16 v[60:63], v[108:111], v[240:243], v[60:63]
    ds_read_b64_tr_b16 v[114:115], v33 offset:2048
    ds_read_b64_tr_b16 v[116:117], v34 offset:0
    s_waitcnt lgkmcnt(14)
    v_mfma_f32_16x16x32_bf16 v[64:67], v[96:99], v[244:247], v[64:67]
    ds_read_b128 v[240:243], v39 offset:24576
    ds_read_b64_tr_b16 v[118:119], v34 offset:2048
    ds_read_b64_tr_b16 v[120:121], v35 offset:0
    v_mfma_f32_16x16x32_bf16 v[68:71], v[100:103], v[244:247], v[68:71]
    ds_read_b64_tr_b16 v[122:123], v35 offset:2048
    ds_read_b64_tr_b16 v[124:125], v36 offset:0
    v_mfma_f32_16x16x32_bf16 v[72:75], v[104:107], v[244:247], v[72:75]
    ds_read_b64_tr_b16 v[126:127], v36 offset:2048
    v_mfma_f32_16x16x32_bf16 v[76:79], v[108:111], v[244:247], v[76:79]
    s_waitcnt lgkmcnt(14)
    v_mfma_f32_16x16x32_bf16 v[48:51], v[176:179], v[248:251], v[48:51]
    ds_read_b128 v[244:247], v39 offset:25600
    s_waitcnt vmcnt(0)
    ds_write_b128 v42, v[128:131] offset:0
    v_mfma_f32_16x16x32_bf16 v[52:55], v[180:183], v[248:251], v[52:55]
    ds_write_b128 v42, v[132:135] offset:1024
    ds_write_b128 v42, v[136:139] offset:2048
    v_mfma_f32_16x16x32_bf16 v[56:59], v[184:187], v[248:251], v[56:59]
    ds_write_b128 v42, v[140:143] offset:3072
    ds_read_b64_tr_b16 v[128:129], v33 offset:0
    v_mfma_f32_16x16x32_bf16 v[60:63], v[188:191], v[248:251], v[60:63]
    ds_read_b64_tr_b16 v[130:131], v33 offset:2048
    ds_read_b64_tr_b16 v[132:133], v34 offset:0
    s_waitcnt lgkmcnt(14)
    v_mfma_f32_16x16x32_bf16 v[64:67], v[176:179], v[252:255], v[64:67]
    ds_read_b128 v[248:251], v39 offset:30720
    ds_read_b64_tr_b16 v[134:135], v34 offset:2048
    ds_read_b64_tr_b16 v[136:137], v35 offset:0
    v_mfma_f32_16x16x32_bf16 v[68:71], v[180:183], v[252:255], v[68:71]
    ds_read_b64_tr_b16 v[138:139], v35 offset:2048
    ds_read_b64_tr_b16 v[140:141], v36 offset:0
    v_mfma_f32_16x16x32_bf16 v[72:75], v[184:187], v[252:255], v[72:75]
    ds_read_b64_tr_b16 v[142:143], v36 offset:2048
    v_mfma_f32_16x16x32_bf16 v[76:79], v[188:191], v[252:255], v[76:79]
    s_waitcnt lgkmcnt(14)
    v_mfma_f32_16x16x32_bf16 v[48:51], v[112:115], v[240:243], v[48:51]
    ds_read_b128 v[252:255], v39 offset:31744
    v_mfma_f32_16x16x32_bf16 v[52:55], v[116:119], v[240:243], v[52:55]
    v_mfma_f32_16x16x32_bf16 v[56:59], v[120:123], v[240:243], v[56:59]
    v_mfma_f32_16x16x32_bf16 v[60:63], v[124:127], v[240:243], v[60:63]
    s_waitcnt lgkmcnt(14)
    v_mfma_f32_16x16x32_bf16 v[64:67], v[112:115], v[244:247], v[64:67]
    ds_read_b128 v[240:243], v39 offset:2048
    v_mfma_f32_16x16x32_bf16 v[68:71], v[116:119], v[244:247], v[68:71]
    v_mfma_f32_16x16x32_bf16 v[72:75], v[120:123], v[244:247], v[72:75]
    v_mfma_f32_16x16x32_bf16 v[76:79], v[124:127], v[244:247], v[76:79]
    s_waitcnt lgkmcnt(2)
    v_mfma_f32_16x16x32_bf16 v[48:51], v[128:131], v[248:251], v[48:51]
    ds_read_b128 v[244:247], v39 offset:3072
    v_mfma_f32_16x16x32_bf16 v[52:55], v[132:135], v[248:251], v[52:55]
    v_mfma_f32_16x16x32_bf16 v[56:59], v[136:139], v[248:251], v[56:59]
    v_mfma_f32_16x16x32_bf16 v[60:63], v[140:143], v[248:251], v[60:63]
    s_waitcnt lgkmcnt(2)
    v_mfma_f32_16x16x32_bf16 v[64:67], v[128:131], v[252:255], v[64:67]
    ds_read_b128 v[248:251], v39 offset:8192
    v_mfma_f32_16x16x32_bf16 v[68:71], v[132:135], v[252:255], v[68:71]
    v_mfma_f32_16x16x32_bf16 v[72:75], v[136:139], v[252:255], v[72:75]
    v_mfma_f32_16x16x32_bf16 v[76:79], v[140:143], v[252:255], v[76:79]
    s_waitcnt lgkmcnt(2)
    v_mfma_f32_16x16x32_bf16 v[80:83], v[192:195], v[240:243], 0
    ds_read_b128 v[252:255], v39 offset:9216
    v_mfma_f32_16x16x32_bf16 v[84:87], v[196:199], v[240:243], 0
    v_mfma_f32_16x16x32_bf16 v[88:91], v[200:203], v[240:243], 0
    v_mfma_f32_16x16x32_bf16 v[92:95], v[204:207], v[240:243], 0
    s_waitcnt lgkmcnt(2)
    v_mfma_f32_16x16x32_bf16 v[144:147], v[192:195], v[244:247], 0
    ds_read_b128 v[240:243], v39 offset:14336
    v_mfma_f32_16x16x32_bf16 v[148:151], v[196:199], v[244:247], 0
    v_mfma_f32_16x16x32_bf16 v[152:155], v[200:203], v[244:247], 0
    v_mfma_f32_16x16x32_bf16 v[156:159], v[204:207], v[244:247], 0
    s_waitcnt lgkmcnt(2)
    v_mfma_f32_16x16x32_bf16 v[80:83], v[208:211], v[248:251], v[80:83]
    ds_read_b128 v[244:247], v39 offset:15360
    v_mul_f32 v48, v48, v44
    v_mul_f32 v49, v49, v44
    v_mfma_f32_16x16x32_bf16 v[84:87], v[212:215], v[248:251], v[84:87]
    v_mul_f32 v50, v50, v44
    v_mul_f32 v51, v51, v44
    v_mfma_f32_16x16x32_bf16 v[88:91], v[216:219], v[248:251], v[88:91]
    v_mul_f32 v52, v52, v44
    v_mul_f32 v53, v53, v44
    v_mfma_f32_16x16x32_bf16 v[92:95], v[220:223], v[248:251], v[92:95]
    v_mul_f32 v54, v54, v44
    v_mul_f32 v55, v55, v44
    s_waitcnt lgkmcnt(2)
    v_mfma_f32_16x16x32_bf16 v[144:147], v[208:211], v[252:255], v[144:147]
    ds_read_b128 v[248:251], v39 offset:38912
    v_cvt_pk_bf16_f32 v48, v48, v49
    v_cvt_pk_bf16_f32 v49, v50, v51
    v_mfma_f32_16x16x32_bf16 v[148:151], v[212:215], v[252:255], v[148:151]
    v_cvt_pk_bf16_f32 v50, v52, v53
    v_cvt_pk_bf16_f32 v51, v54, v55
    v_mfma_f32_16x16x32_bf16 v[152:155], v[216:219], v[252:255], v[152:155]
    s_add_u32 s57, s56, 0
    buffer_store_dwordx4 v[48:51], v18, s[28:31], s57 offen offset:0 sc1
    v_mul_f32 v56, v56, v44
    v_mfma_f32_16x16x32_bf16 v[156:159], v[220:223], v[252:255], v[156:159]
    v_mul_f32 v57, v57, v44
    v_mul_f32 v58, v58, v44
    s_waitcnt lgkmcnt(2)
    v_mfma_f32_16x16x32_bf16 v[80:83], v[224:227], v[240:243], v[80:83]
    ds_read_b128 v[252:255], v39 offset:39936
    v_mul_f32 v59, v59, v44
    v_mul_f32 v60, v60, v44
    v_mfma_f32_16x16x32_bf16 v[84:87], v[228:231], v[240:243], v[84:87]
    v_mul_f32 v61, v61, v44
    v_mul_f32 v62, v62, v44
    v_mfma_f32_16x16x32_bf16 v[88:91], v[232:235], v[240:243], v[88:91]
    v_mul_f32 v63, v63, v44
    v_cvt_pk_bf16_f32 v56, v56, v57
    v_mfma_f32_16x16x32_bf16 v[92:95], v[236:239], v[240:243], v[92:95]
    v_cvt_pk_bf16_f32 v57, v58, v59
    v_cvt_pk_bf16_f32 v58, v60, v61
    s_waitcnt lgkmcnt(2)
    v_mfma_f32_16x16x32_bf16 v[144:147], v[224:227], v[244:247], v[144:147]
    ds_read_b128 v[240:243], v39 offset:20480
    v_cvt_pk_bf16_f32 v59, v62, v63
    s_add_u32 s57, s56, 0
    buffer_store_dwordx4 v[56:59], v18, s[28:31], s57 offen offset:1024 sc1
    v_mfma_f32_16x16x32_bf16 v[148:151], v[228:231], v[244:247], v[148:151]
    v_mul_f32 v64, v64, v45
    v_mul_f32 v65, v65, v45
    v_mfma_f32_16x16x32_bf16 v[152:155], v[232:235], v[244:247], v[152:155]
    v_mul_f32 v66, v66, v45
    v_mul_f32 v67, v67, v45
    v_mfma_f32_16x16x32_bf16 v[156:159], v[236:239], v[244:247], v[156:159]
    v_mul_f32 v68, v68, v45
    v_mul_f32 v69, v69, v45
    s_waitcnt lgkmcnt(2)
    v_mfma_f32_16x16x32_bf16 v[80:83], v[160:163], v[248:251], v[80:83]
    ds_read_b128 v[244:247], v39 offset:21504
    v_mul_f32 v70, v70, v45
    v_mul_f32 v71, v71, v45
    v_mfma_f32_16x16x32_bf16 v[84:87], v[164:167], v[248:251], v[84:87]
    v_cvt_pk_bf16_f32 v64, v64, v65
    v_cvt_pk_bf16_f32 v65, v66, v67
    v_mfma_f32_16x16x32_bf16 v[88:91], v[168:171], v[248:251], v[88:91]
    v_cvt_pk_bf16_f32 v66, v68, v69
    v_cvt_pk_bf16_f32 v67, v70, v71
    v_mfma_f32_16x16x32_bf16 v[92:95], v[172:175], v[248:251], v[92:95]
    s_add_u32 s57, s56, 0
    buffer_store_dwordx4 v[64:67], v18, s[28:31], s57 offen offset:2048 sc1
    v_mul_f32 v72, v72, v45
    s_waitcnt lgkmcnt(2)
    v_mfma_f32_16x16x32_bf16 v[144:147], v[160:163], v[252:255], v[144:147]
    ds_read_b128 v[248:251], v39 offset:45056
    v_mul_f32 v73, v73, v45
    v_mul_f32 v74, v74, v45
    v_mfma_f32_16x16x32_bf16 v[148:151], v[164:167], v[252:255], v[148:151]
    v_mul_f32 v75, v75, v45
    v_mul_f32 v76, v76, v45
    v_mfma_f32_16x16x32_bf16 v[152:155], v[168:171], v[252:255], v[152:155]
    v_mul_f32 v77, v77, v45
    v_mul_f32 v78, v78, v45
    v_mfma_f32_16x16x32_bf16 v[156:159], v[172:175], v[252:255], v[156:159]
    v_mul_f32 v79, v79, v45
    v_cvt_pk_bf16_f32 v72, v72, v73
    s_waitcnt lgkmcnt(2)
    v_mfma_f32_16x16x32_bf16 v[80:83], v[96:99], v[240:243], v[80:83]
    ds_read_b128 v[252:255], v39 offset:46080
    v_cvt_pk_bf16_f32 v73, v74, v75
    v_cvt_pk_bf16_f32 v74, v76, v77
    v_mfma_f32_16x16x32_bf16 v[84:87], v[100:103], v[240:243], v[84:87]
    v_cvt_pk_bf16_f32 v75, v78, v79
    s_add_u32 s57, s56, 0
    buffer_store_dwordx4 v[72:75], v18, s[28:31], s57 offen offset:3072 sc1
    v_mfma_f32_16x16x32_bf16 v[88:91], v[104:107], v[240:243], v[88:91]
    v_mfma_f32_16x16x32_bf16 v[92:95], v[108:111], v[240:243], v[92:95]
    s_waitcnt lgkmcnt(2)
    v_mfma_f32_16x16x32_bf16 v[144:147], v[96:99], v[244:247], v[144:147]
    ds_read_b128 v[240:243], v39 offset:26624
    v_mfma_f32_16x16x32_bf16 v[148:151], v[100:103], v[244:247], v[148:151]
    v_mfma_f32_16x16x32_bf16 v[152:155], v[104:107], v[244:247], v[152:155]
    v_mfma_f32_16x16x32_bf16 v[156:159], v[108:111], v[244:247], v[156:159]
    s_waitcnt lgkmcnt(2)
    v_mfma_f32_16x16x32_bf16 v[80:83], v[176:179], v[248:251], v[80:83]
    ds_read_b128 v[244:247], v39 offset:27648
    v_mfma_f32_16x16x32_bf16 v[84:87], v[180:183], v[248:251], v[84:87]
    v_mfma_f32_16x16x32_bf16 v[88:91], v[184:187], v[248:251], v[88:91]
    v_mfma_f32_16x16x32_bf16 v[92:95], v[188:191], v[248:251], v[92:95]
    s_waitcnt lgkmcnt(2)
    v_mfma_f32_16x16x32_bf16 v[144:147], v[176:179], v[252:255], v[144:147]
    ds_read_b128 v[248:251], v39 offset:32768
    v_mfma_f32_16x16x32_bf16 v[148:151], v[180:183], v[252:255], v[148:151]
    v_mfma_f32_16x16x32_bf16 v[152:155], v[184:187], v[252:255], v[152:155]
    v_mfma_f32_16x16x32_bf16 v[156:159], v[188:191], v[252:255], v[156:159]
    s_waitcnt lgkmcnt(2)
    v_mfma_f32_16x16x32_bf16 v[80:83], v[112:115], v[240:243], v[80:83]
    ds_read_b128 v[252:255], v39 offset:33792
    v_mfma_f32_16x16x32_bf16 v[84:87], v[116:119], v[240:243], v[84:87]
    v_mfma_f32_16x16x32_bf16 v[88:91], v[120:123], v[240:243], v[88:91]
    v_mfma_f32_16x16x32_bf16 v[92:95], v[124:127], v[240:243], v[92:95]
    s_waitcnt lgkmcnt(2)
    v_mfma_f32_16x16x32_bf16 v[144:147], v[112:115], v[244:247], v[144:147]
    ds_read_b128 v[240:243], v39 offset:4096
    v_mfma_f32_16x16x32_bf16 v[148:151], v[116:119], v[244:247], v[148:151]
    v_mfma_f32_16x16x32_bf16 v[152:155], v[120:123], v[244:247], v[152:155]
    v_mfma_f32_16x16x32_bf16 v[156:159], v[124:127], v[244:247], v[156:159]
    s_waitcnt lgkmcnt(2)
    v_mfma_f32_16x16x32_bf16 v[80:83], v[128:131], v[248:251], v[80:83]
    ds_read_b128 v[244:247], v39 offset:10240
    v_mfma_f32_16x16x32_bf16 v[84:87], v[132:135], v[248:251], v[84:87]
    v_mfma_f32_16x16x32_bf16 v[88:91], v[136:139], v[248:251], v[88:91]
    v_mfma_f32_16x16x32_bf16 v[92:95], v[140:143], v[248:251], v[92:95]
    s_waitcnt lgkmcnt(2)
    v_mfma_f32_16x16x32_bf16 v[144:147], v[128:131], v[252:255], v[144:147]
    ds_read_b128 v[248:251], v39 offset:16384
    v_mfma_f32_16x16x32_bf16 v[148:151], v[132:135], v[252:255], v[148:151]
    v_mfma_f32_16x16x32_bf16 v[152:155], v[136:139], v[252:255], v[152:155]
    v_mfma_f32_16x16x32_bf16 v[156:159], v[140:143], v[252:255], v[156:159]
    s_waitcnt lgkmcnt(2)
    v_mfma_f32_16x16x32_bf16 v[48:51], v[192:195], v[240:243], 0
    ds_read_b128 v[252:255], v39 offset:40960
    v_mfma_f32_16x16x32_bf16 v[52:55], v[196:199], v[240:243], 0
    v_mfma_f32_16x16x32_bf16 v[56:59], v[200:203], v[240:243], 0
    v_mfma_f32_16x16x32_bf16 v[60:63], v[204:207], v[240:243], 0
    s_waitcnt lgkmcnt(2)
    v_mfma_f32_16x16x32_bf16 v[48:51], v[208:211], v[244:247], v[48:51]
    ds_read_b128 v[240:243], v39 offset:22528
    v_mfma_f32_16x16x32_bf16 v[52:55], v[212:215], v[244:247], v[52:55]
    v_mfma_f32_16x16x32_bf16 v[56:59], v[216:219], v[244:247], v[56:59]
    v_mfma_f32_16x16x32_bf16 v[60:63], v[220:223], v[244:247], v[60:63]
    s_waitcnt lgkmcnt(2)
    v_mfma_f32_16x16x32_bf16 v[48:51], v[224:227], v[248:251], v[48:51]
    ds_read_b128 v[244:247], v39 offset:47104
    v_mul_f32 v80, v80, v46
    v_mul_f32 v81, v81, v46
    v_mfma_f32_16x16x32_bf16 v[52:55], v[228:231], v[248:251], v[52:55]
    v_mul_f32 v82, v82, v46
    v_mul_f32 v83, v83, v46
    v_mfma_f32_16x16x32_bf16 v[56:59], v[232:235], v[248:251], v[56:59]
    v_mul_f32 v84, v84, v46
    v_mul_f32 v85, v85, v46
    v_mfma_f32_16x16x32_bf16 v[60:63], v[236:239], v[248:251], v[60:63]
    v_mul_f32 v86, v86, v46
    v_mul_f32 v87, v87, v46
    s_waitcnt lgkmcnt(2)
    v_mfma_f32_16x16x32_bf16 v[48:51], v[160:163], v[252:255], v[48:51]
    ds_read_b128 v[248:251], v39 offset:28672
    v_cvt_pk_bf16_f32 v80, v80, v81
    v_cvt_pk_bf16_f32 v81, v82, v83
    v_mfma_f32_16x16x32_bf16 v[52:55], v[164:167], v[252:255], v[52:55]
    v_cvt_pk_bf16_f32 v82, v84, v85
    v_cvt_pk_bf16_f32 v83, v86, v87
    v_mfma_f32_16x16x32_bf16 v[56:59], v[168:171], v[252:255], v[56:59]
    s_add_u32 s57, s56, 4096
    buffer_store_dwordx4 v[80:83], v18, s[28:31], s57 offen offset:0 sc1
    v_mul_f32 v88, v88, v46
    v_mfma_f32_16x16x32_bf16 v[60:63], v[172:175], v[252:255], v[60:63]
    v_mul_f32 v89, v89, v46
    v_mul_f32 v90, v90, v46
    s_waitcnt lgkmcnt(2)
    v_mfma_f32_16x16x32_bf16 v[48:51], v[96:99], v[240:243], v[48:51]
    ds_read_b128 v[252:255], v39 offset:34816
    v_mul_f32 v91, v91, v46
    v_mul_f32 v92, v92, v46
    v_mfma_f32_16x16x32_bf16 v[52:55], v[100:103], v[240:243], v[52:55]
    v_mul_f32 v93, v93, v46
    v_mul_f32 v94, v94, v46
    v_mfma_f32_16x16x32_bf16 v[56:59], v[104:107], v[240:243], v[56:59]
    v_mul_f32 v95, v95, v46
    v_cvt_pk_bf16_f32 v88, v88, v89
    v_mfma_f32_16x16x32_bf16 v[60:63], v[108:111], v[240:243], v[60:63]
    v_cvt_pk_bf16_f32 v89, v90, v91
    v_cvt_pk_bf16_f32 v90, v92, v93
    s_waitcnt lgkmcnt(2)
    v_mfma_f32_16x16x32_bf16 v[48:51], v[176:179], v[244:247], v[48:51]
    ds_read_b128 v[240:243], v39 offset:5120
    v_cvt_pk_bf16_f32 v91, v94, v95
    s_add_u32 s57, s56, 4096
    buffer_store_dwordx4 v[88:91], v18, s[28:31], s57 offen offset:1024 sc1
    v_mfma_f32_16x16x32_bf16 v[52:55], v[180:183], v[244:247], v[52:55]
    v_mul_f32 v144, v144, v47
    v_mul_f32 v145, v145, v47
    v_mfma_f32_16x16x32_bf16 v[56:59], v[184:187], v[244:247], v[56:59]
    v_mul_f32 v146, v146, v47
    v_mul_f32 v147, v147, v47
    v_mfma_f32_16x16x32_bf16 v[60:63], v[188:191], v[244:247], v[60:63]
    v_mul_f32 v148, v148, v47
    v_mul_f32 v149, v149, v47
    s_waitcnt lgkmcnt(2)
    v_mfma_f32_16x16x32_bf16 v[48:51], v[112:115], v[248:251], v[48:51]
    ds_read_b128 v[244:247], v39 offset:11264
    v_mul_f32 v150, v150, v47
    v_mul_f32 v151, v151, v47
    v_mfma_f32_16x16x32_bf16 v[52:55], v[116:119], v[248:251], v[52:55]
    v_cvt_pk_bf16_f32 v144, v144, v145
    v_cvt_pk_bf16_f32 v145, v146, v147
    v_mfma_f32_16x16x32_bf16 v[56:59], v[120:123], v[248:251], v[56:59]
    v_cvt_pk_bf16_f32 v146, v148, v149
    v_cvt_pk_bf16_f32 v147, v150, v151
    v_mfma_f32_16x16x32_bf16 v[60:63], v[124:127], v[248:251], v[60:63]
    s_add_u32 s57, s56, 4096
    buffer_store_dwordx4 v[144:147], v18, s[28:31], s57 offen offset:2048 sc1
    v_mul_f32 v152, v152, v47
    s_waitcnt lgkmcnt(2)
    v_mfma_f32_16x16x32_bf16 v[48:51], v[128:131], v[252:255], v[48:51]
    ds_read_b128 v[248:251], v39 offset:17408
    v_mul_f32 v153, v153, v47
    v_mul_f32 v154, v154, v47
    v_mfma_f32_16x16x32_bf16 v[52:55], v[132:135], v[252:255], v[52:55]
    v_mul_f32 v155, v155, v47
    v_mul_f32 v156, v156, v47
    v_mfma_f32_16x16x32_bf16 v[56:59], v[136:139], v[252:255], v[56:59]
    v_mul_f32 v157, v157, v47
    v_mul_f32 v158, v158, v47
    v_mfma_f32_16x16x32_bf16 v[60:63], v[140:143], v[252:255], v[60:63]
    v_mul_f32 v159, v159, v47
    v_cvt_pk_bf16_f32 v152, v152, v153
    s_waitcnt lgkmcnt(2)
    v_mfma_f32_16x16x32_bf16 v[64:67], v[192:195], v[240:243], 0
    ds_read_b128 v[252:255], v39 offset:41984
    v_cvt_pk_bf16_f32 v153, v154, v155
    v_cvt_pk_bf16_f32 v154, v156, v157
    v_mfma_f32_16x16x32_bf16 v[68:71], v[196:199], v[240:243], 0
    v_cvt_pk_bf16_f32 v155, v158, v159
    s_add_u32 s57, s56, 4096
    buffer_store_dwordx4 v[152:155], v18, s[28:31], s57 offen offset:3072 sc1
    v_mfma_f32_16x16x32_bf16 v[72:75], v[200:203], v[240:243], 0
    v_mfma_f32_16x16x32_bf16 v[76:79], v[204:207], v[240:243], 0
    s_waitcnt lgkmcnt(2)
    v_mfma_f32_16x16x32_bf16 v[64:67], v[208:211], v[244:247], v[64:67]
    ds_read_b128 v[240:243], v39 offset:23552
    v_mfma_f32_16x16x32_bf16 v[68:71], v[212:215], v[244:247], v[68:71]
    v_mfma_f32_16x16x32_bf16 v[72:75], v[216:219], v[244:247], v[72:75]
    v_mfma_f32_16x16x32_bf16 v[76:79], v[220:223], v[244:247], v[76:79]
    s_waitcnt lgkmcnt(2)
    v_mfma_f32_16x16x32_bf16 v[64:67], v[224:227], v[248:251], v[64:67]
    ds_read_b128 v[244:247], v39 offset:48128
    v_mul_f32 v48, v48, v8
    v_mul_f32 v49, v49, v8
    v_mfma_f32_16x16x32_bf16 v[68:71], v[228:231], v[248:251], v[68:71]
    v_mul_f32 v50, v50, v8
    v_mul_f32 v51, v51, v8
    v_mfma_f32_16x16x32_bf16 v[72:75], v[232:235], v[248:251], v[72:75]
    v_mul_f32 v52, v52, v8
    v_mul_f32 v53, v53, v8
    v_mfma_f32_16x16x32_bf16 v[76:79], v[236:239], v[248:251], v[76:79]
    v_mul_f32 v54, v54, v8
    v_mul_f32 v55, v55, v8
    s_waitcnt lgkmcnt(2)
    v_mfma_f32_16x16x32_bf16 v[64:67], v[160:163], v[252:255], v[64:67]
    ds_read_b128 v[248:251], v39 offset:29696
    v_cvt_pk_bf16_f32 v48, v48, v49
    v_cvt_pk_bf16_f32 v49, v50, v51
    v_mfma_f32_16x16x32_bf16 v[68:71], v[164:167], v[252:255], v[68:71]
    v_cvt_pk_bf16_f32 v50, v52, v53
    v_cvt_pk_bf16_f32 v51, v54, v55
    v_mfma_f32_16x16x32_bf16 v[72:75], v[168:171], v[252:255], v[72:75]
    s_add_u32 s57, s56, 8192
    buffer_store_dwordx4 v[48:51], v18, s[28:31], s57 offen offset:0 sc1
    v_mul_f32 v56, v56, v8
    v_mfma_f32_16x16x32_bf16 v[76:79], v[172:175], v[252:255], v[76:79]
    v_mul_f32 v57, v57, v8
    v_mul_f32 v58, v58, v8
    s_waitcnt lgkmcnt(2)
    v_mfma_f32_16x16x32_bf16 v[64:67], v[96:99], v[240:243], v[64:67]
    ds_read_b128 v[252:255], v39 offset:35840
    v_mul_f32 v59, v59, v8
    v_mul_f32 v60, v60, v8
    v_mfma_f32_16x16x32_bf16 v[68:71], v[100:103], v[240:243], v[68:71]
    v_mul_f32 v61, v61, v8
    v_mul_f32 v62, v62, v8
    v_mfma_f32_16x16x32_bf16 v[72:75], v[104:107], v[240:243], v[72:75]
    v_mul_f32 v63, v63, v8
    v_cvt_pk_bf16_f32 v56, v56, v57
    v_mfma_f32_16x16x32_bf16 v[76:79], v[108:111], v[240:243], v[76:79]
    v_cvt_pk_bf16_f32 v57, v58, v59
    v_cvt_pk_bf16_f32 v58, v60, v61
    s_waitcnt lgkmcnt(2)
    v_mfma_f32_16x16x32_bf16 v[64:67], v[176:179], v[244:247], v[64:67]
    v_cvt_pk_bf16_f32 v59, v62, v63
    s_add_u32 s57, s56, 8192
    buffer_store_dwordx4 v[56:59], v18, s[28:31], s57 offen offset:1024 sc1
    v_mfma_f32_16x16x32_bf16 v[68:71], v[180:183], v[244:247], v[68:71]
    v_mfma_f32_16x16x32_bf16 v[72:75], v[184:187], v[244:247], v[72:75]
    v_mfma_f32_16x16x32_bf16 v[76:79], v[188:191], v[244:247], v[76:79]
    s_waitcnt lgkmcnt(1)
    v_mfma_f32_16x16x32_bf16 v[64:67], v[112:115], v[248:251], v[64:67]
    v_mfma_f32_16x16x32_bf16 v[68:71], v[116:119], v[248:251], v[68:71]
    v_mfma_f32_16x16x32_bf16 v[72:75], v[120:123], v[248:251], v[72:75]
    v_mfma_f32_16x16x32_bf16 v[76:79], v[124:127], v[248:251], v[76:79]
    s_waitcnt lgkmcnt(0)
    v_mfma_f32_16x16x32_bf16 v[64:67], v[128:131], v[252:255], v[64:67]
    v_mfma_f32_16x16x32_bf16 v[68:71], v[132:135], v[252:255], v[68:71]
    v_mfma_f32_16x16x32_bf16 v[72:75], v[136:139], v[252:255], v[72:75]
    v_mfma_f32_16x16x32_bf16 v[76:79], v[140:143], v[252:255], v[76:79]
    s_nop 7
    v_mul_f32 v64, v64, v9
    v_mul_f32 v65, v65, v9
    v_mul_f32 v66, v66, v9
    v_mul_f32 v67, v67, v9
    v_mul_f32 v68, v68, v9
    v_mul_f32 v69, v69, v9
    v_mul_f32 v70, v70, v9
    v_mul_f32 v71, v71, v9
    v_cvt_pk_bf16_f32 v64, v64, v65
    v_cvt_pk_bf16_f32 v65, v66, v67
    v_cvt_pk_bf16_f32 v66, v68, v69
    v_cvt_pk_bf16_f32 v67, v70, v71
    s_add_u32 s57, s56, 8192
    buffer_store_dwordx4 v[64:67], v18, s[28:31], s57 offen offset:2048 sc1
    v_mul_f32 v72, v72, v9
    v_mul_f32 v73, v73, v9
    v_mul_f32 v74, v74, v9
    v_mul_f32 v75, v75, v9
    v_mul_f32 v76, v76, v9
    v_mul_f32 v77, v77, v9
    v_mul_f32 v78, v78, v9
    v_mul_f32 v79, v79, v9
    v_cvt_pk_bf16_f32 v72, v72, v73
    v_cvt_pk_bf16_f32 v73, v74, v75
    v_cvt_pk_bf16_f32 v74, v76, v77
    v_cvt_pk_bf16_f32 v75, v78, v79
    s_add_u32 s57, s56, 8192
    buffer_store_dwordx4 v[72:75], v18, s[28:31], s57 offen offset:3072 sc1
    s_setprio 0
    v_mov_b32 v14, 1
    s_lshl_b32 s3, s7, 2
    v_lshlrev_b32 v16, 8, v2
    v_add_u32 v16, s3, v16
    s_lshl_b32 s3, 1, s7
    v_mov_b32 v17, s3
    s_mov_b64 exec, 1
    s_waitcnt vmcnt(0)
    ds_add_rtn_u32 v15, v12, v14 offset:4
    s_waitcnt lgkmcnt(0)
    v_readfirstlane_b32 s3, v15
    s_cmp_lg_u32 s3, 6
    s_cbranch_scc1 L_nosig
    ds_or_b32 v12, v17
    s_mov_b64 exec, 1
    global_store_dword v16, v14, s[32:33] sc1
L_nosig:
    s_mov_b64 exec, -1
    s_cmp_ge_u32 s4, 6
    s_cbranch_scc1 L_fin
    v_cmp_gt_u32 vcc, 336, v0
    s_mov_b32 s16, s60
    s_mov_b32 s17, s61
    s_mov_b32 s18, 1376256
    s_and_saveexec_b64 s[56:57], vcc
    s_mov_b32 s34, 0
    s_mov_b32 s36, 0
    s_mov_b32 s58, 0xffff0000
L_red:
    ds_read_b32 v45, v12
    s_waitcnt lgkmcnt(0)
    v_readfirstlane_b32 s35, v45
    s_add_u32 s36, s36, 1
    s_bitcmp1_b32 s35, s7
    s_cbranch_scc0 L_red_next
    s_andn2_b32 s37, s35, s34
    s_cbranch_scc0 L_red_next
    s_bitcmp1_b32 s37, 0
    s_cbranch_scc0 L_red_s0
    s_mov_b32 s53, 0
    buffer_load_dwordx4 v[48:51], v40, s[28:31], s53 offen sc1
L_red_s0:
    s_bitcmp1_b32 s37, 1
    s_cbranch_scc0 L_red_s1
    s_mov_b32 s53, 86016
    buffer_load_dwordx4 v[52:55], v40, s[28:31], s53 offen sc1
L_red_s1:
    s_bitcmp1_b32 s37, 2
    s_cbranch_scc0 L_red_s2
    s_mov_b32 s53, 172032
    buffer_load_dwordx4 v[56:59], v40, s[28:31], s53 offen sc1
L_red_s2:
    s_bitcmp1_b32 s37, 3
    s_cbranch_scc0 L_red_s3
    s_mov_b32 s53, 258048
    buffer_load_dwordx4 v[60:63], v40, s[28:31], s53 offen sc1
L_red_s3:
    s_bitcmp1_b32 s37, 4
    s_cbranch_scc0 L_red_s4
    s_mov_b32 s53, 344064
    buffer_load_dwordx4 v[64:67], v40, s[28:31], s53 offen sc1
L_red_s4:
    s_bitcmp1_b32 s37, 5
    s_cbranch_scc0 L_red_s5
    s_mov_b32 s53, 430080
    buffer_load_dwordx4 v[68:71], v40, s[28:31], s53 offen sc1
L_red_s5:
    s_bitcmp1_b32 s37, 6
    s_cbranch_scc0 L_red_s6
    s_mov_b32 s53, 516096
    buffer_load_dwordx4 v[72:75], v40, s[28:31], s53 offen sc1
L_red_s6:
    s_bitcmp1_b32 s37, 7
    s_cbranch_scc0 L_red_s7
    s_mov_b32 s53, 602112
    buffer_load_dwordx4 v[76:79], v40, s[28:31], s53 offen sc1
L_red_s7:
    s_bitcmp1_b32 s37, 8
    s_cbranch_scc0 L_red_s8
    s_mov_b32 s53, 688128
    buffer_load_dwordx4 v[80:83], v40, s[28:31], s53 offen sc1
L_red_s8:
    s_bitcmp1_b32 s37, 9
    s_cbranch_scc0 L_red_s9
    s_mov_b32 s53, 774144
    buffer_load_dwordx4 v[84:87], v40, s[28:31], s53 offen sc1
L_red_s9:
    s_bitcmp1_b32 s37, 10
    s_cbranch_scc0 L_red_s10
    s_mov_b32 s53, 860160
    buffer_load_dwordx4 v[88:91], v40, s[28:31], s53 offen sc1
L_red_s10:
    s_bitcmp1_b32 s37, 11
    s_cbranch_scc0 L_red_s11
    s_mov_b32 s53, 946176
    buffer_load_dwordx4 v[92:95], v40, s[28:31], s53 offen sc1
L_red_s11:
    s_bitcmp1_b32 s37, 12
    s_cbranch_scc0 L_red_s12
    s_mov_b32 s53, 1032192
    buffer_load_dwordx4 v[96:99], v40, s[28:31], s53 offen sc1
L_red_s12:
    s_bitcmp1_b32 s37, 13
    s_cbranch_scc0 L_red_s13
    s_mov_b32 s53, 1118208
    buffer_load_dwordx4 v[100:103], v40, s[28:31], s53 offen sc1
L_red_s13:
    s_bitcmp1_b32 s37, 14
    s_cbranch_scc0 L_red_s14
    s_mov_b32 s53, 1204224
    buffer_load_dwordx4 v[104:107], v40, s[28:31], s53 offen sc1
L_red_s14:
    s_bitcmp1_b32 s37, 15
    s_cbranch_scc0 L_red_s15
    s_mov_b32 s53, 1290240
    buffer_load_dwordx4 v[108:111], v40, s[28:31], s53 offen sc1
L_red_s15:
    s_or_b32 s34, s34, s37
    s_cmp_eq_u32 s34, 0xffff
    s_cbranch_scc1 L_red_done
L_red_next:
    s_sleep 1
    s_cmp_lt_u32 s36, 0x400000
    s_cbranch_scc1 L_red
L_red_done:
    s_waitcnt vmcnt(0)
    v_lshlrev_b32 v120, 16, v48
    v_and_b32 v121, s58, v48
    v_lshlrev_b32 v122, 16, v49
    v_and_b32 v123, s58, v49
    v_lshlrev_b32 v124, 16, v50
    v_and_b32 v125, s58, v50
    v_lshlrev_b32 v126, 16, v51
    v_and_b32 v127, s58, v51
    v_lshlrev_b32 v128, 16, v52
    v_and_b32 v129, s58, v52
    v_lshlrev_b32 v130, 16, v53
    v_and_b32 v131, s58, v53
    v_lshlrev_b32 v132, 16, v54
    v_and_b32 v133, s58, v54
    v_lshlrev_b32 v134, 16, v55
    v_and_b32 v135, s58, v55
    v_pk_add_f32 v[120:121], v[120:121], v[128:129]
    v_pk_add_f32 v[122:123], v[122:123], v[130:131]
    v_pk_add_f32 v[124:125], v[124:125], v[132:133]
    v_pk_add_f32 v[126:127], v[126:127], v[134:135]
    v_lshlrev_b32 v128, 16, v56
    v_and_b32 v129, s58, v56
    v_lshlrev_b32 v130, 16, v57
    v_and_b32 v131, s58, v57
    v_lshlrev_b32 v132, 16, v58
    v_and_b32 v133, s58, v58
    v_lshlrev_b32 v134, 16, v59
    v_and_b32 v135, s58, v59
    v_pk_add_f32 v[120:121], v[120:121], v[128:129]
    v_pk_add_f32 v[122:123], v[122:123], v[130:131]
    v_pk_add_f32 v[124:125], v[124:125], v[132:133]
    v_pk_add_f32 v[126:127], v[126:127], v[134:135]
    v_lshlrev_b32 v128, 16, v60
    v_and_b32 v129, s58, v60
    v_lshlrev_b32 v130, 16, v61
    v_and_b32 v131, s58, v61
    v_lshlrev_b32 v132, 16, v62
    v_and_b32 v133, s58, v62
    v_lshlrev_b32 v134, 16, v63
    v_and_b32 v135, s58, v63
    v_pk_add_f32 v[120:121], v[120:121], v[128:129]
    v_pk_add_f32 v[122:123], v[122:123], v[130:131]
    v_pk_add_f32 v[124:125], v[124:125], v[132:133]
    v_pk_add_f32 v[126:127], v[126:127], v[134:135]
    v_lshlrev_b32 v128, 16, v64
    v_and_b32 v129, s58, v64
    v_lshlrev_b32 v130, 16, v65
    v_and_b32 v131, s58, v65
    v_lshlrev_b32 v132, 16, v66
    v_and_b32 v133, s58, v66
    v_lshlrev_b32 v134, 16, v67
    v_and_b32 v135, s58, v67
    v_pk_add_f32 v[120:121], v[120:121], v[128:129]
    v_pk_add_f32 v[122:123], v[122:123], v[130:131]
    v_pk_add_f32 v[124:125], v[124:125], v[132:133]
    v_pk_add_f32 v[126:127], v[126:127], v[134:135]
    v_lshlrev_b32 v128, 16, v68
    v_and_b32 v129, s58, v68
    v_lshlrev_b32 v130, 16, v69
    v_and_b32 v131, s58, v69
    v_lshlrev_b32 v132, 16, v70
    v_and_b32 v133, s58, v70
    v_lshlrev_b32 v134, 16, v71
    v_and_b32 v135, s58, v71
    v_pk_add_f32 v[120:121], v[120:121], v[128:129]
    v_pk_add_f32 v[122:123], v[122:123], v[130:131]
    v_pk_add_f32 v[124:125], v[124:125], v[132:133]
    v_pk_add_f32 v[126:127], v[126:127], v[134:135]
    v_lshlrev_b32 v128, 16, v72
    v_and_b32 v129, s58, v72
    v_lshlrev_b32 v130, 16, v73
    v_and_b32 v131, s58, v73
    v_lshlrev_b32 v132, 16, v74
    v_and_b32 v133, s58, v74
    v_lshlrev_b32 v134, 16, v75
    v_and_b32 v135, s58, v75
    v_pk_add_f32 v[120:121], v[120:121], v[128:129]
    v_pk_add_f32 v[122:123], v[122:123], v[130:131]
    v_pk_add_f32 v[124:125], v[124:125], v[132:133]
    v_pk_add_f32 v[126:127], v[126:127], v[134:135]
    v_lshlrev_b32 v128, 16, v76
    v_and_b32 v129, s58, v76
    v_lshlrev_b32 v130, 16, v77
    v_and_b32 v131, s58, v77
    v_lshlrev_b32 v132, 16, v78
    v_and_b32 v133, s58, v78
    v_lshlrev_b32 v134, 16, v79
    v_and_b32 v135, s58, v79
    v_pk_add_f32 v[120:121], v[120:121], v[128:129]
    v_pk_add_f32 v[122:123], v[122:123], v[130:131]
    v_pk_add_f32 v[124:125], v[124:125], v[132:133]
    v_pk_add_f32 v[126:127], v[126:127], v[134:135]
    v_lshlrev_b32 v128, 16, v80
    v_and_b32 v129, s58, v80
    v_lshlrev_b32 v130, 16, v81
    v_and_b32 v131, s58, v81
    v_lshlrev_b32 v132, 16, v82
    v_and_b32 v133, s58, v82
    v_lshlrev_b32 v134, 16, v83
    v_and_b32 v135, s58, v83
    v_pk_add_f32 v[120:121], v[120:121], v[128:129]
    v_pk_add_f32 v[122:123], v[122:123], v[130:131]
    v_pk_add_f32 v[124:125], v[124:125], v[132:133]
    v_pk_add_f32 v[126:127], v[126:127], v[134:135]
    v_lshlrev_b32 v128, 16, v84
    v_and_b32 v129, s58, v84
    v_lshlrev_b32 v130, 16, v85
    v_and_b32 v131, s58, v85
    v_lshlrev_b32 v132, 16, v86
    v_and_b32 v133, s58, v86
    v_lshlrev_b32 v134, 16, v87
    v_and_b32 v135, s58, v87
    v_pk_add_f32 v[120:121], v[120:121], v[128:129]
    v_pk_add_f32 v[122:123], v[122:123], v[130:131]
    v_pk_add_f32 v[124:125], v[124:125], v[132:133]
    v_pk_add_f32 v[126:127], v[126:127], v[134:135]
    v_lshlrev_b32 v128, 16, v88
    v_and_b32 v129, s58, v88
    v_lshlrev_b32 v130, 16, v89
    v_and_b32 v131, s58, v89
    v_lshlrev_b32 v132, 16, v90
    v_and_b32 v133, s58, v90
    v_lshlrev_b32 v134, 16, v91
    v_and_b32 v135, s58, v91
    v_pk_add_f32 v[120:121], v[120:121], v[128:129]
    v_pk_add_f32 v[122:123], v[122:123], v[130:131]
    v_pk_add_f32 v[124:125], v[124:125], v[132:133]
    v_pk_add_f32 v[126:127], v[126:127], v[134:135]
    v_lshlrev_b32 v128, 16, v92
    v_and_b32 v129, s58, v92
    v_lshlrev_b32 v130, 16, v93
    v_and_b32 v131, s58, v93
    v_lshlrev_b32 v132, 16, v94
    v_and_b32 v133, s58, v94
    v_lshlrev_b32 v134, 16, v95
    v_and_b32 v135, s58, v95
    v_pk_add_f32 v[120:121], v[120:121], v[128:129]
    v_pk_add_f32 v[122:123], v[122:123], v[130:131]
    v_pk_add_f32 v[124:125], v[124:125], v[132:133]
    v_pk_add_f32 v[126:127], v[126:127], v[134:135]
    v_lshlrev_b32 v128, 16, v96
    v_and_b32 v129, s58, v96
    v_lshlrev_b32 v130, 16, v97
    v_and_b32 v131, s58, v97
    v_lshlrev_b32 v132, 16, v98
    v_and_b32 v133, s58, v98
    v_lshlrev_b32 v134, 16, v99
    v_and_b32 v135, s58, v99
    v_pk_add_f32 v[120:121], v[120:121], v[128:129]
    v_pk_add_f32 v[122:123], v[122:123], v[130:131]
    v_pk_add_f32 v[124:125], v[124:125], v[132:133]
    v_pk_add_f32 v[126:127], v[126:127], v[134:135]
    v_lshlrev_b32 v128, 16, v100
    v_and_b32 v129, s58, v100
    v_lshlrev_b32 v130, 16, v101
    v_and_b32 v131, s58, v101
    v_lshlrev_b32 v132, 16, v102
    v_and_b32 v133, s58, v102
    v_lshlrev_b32 v134, 16, v103
    v_and_b32 v135, s58, v103
    v_pk_add_f32 v[120:121], v[120:121], v[128:129]
    v_pk_add_f32 v[122:123], v[122:123], v[130:131]
    v_pk_add_f32 v[124:125], v[124:125], v[132:133]
    v_pk_add_f32 v[126:127], v[126:127], v[134:135]
    v_lshlrev_b32 v128, 16, v104
    v_and_b32 v129, s58, v104
    v_lshlrev_b32 v130, 16, v105
    v_and_b32 v131, s58, v105
    v_lshlrev_b32 v132, 16, v106
    v_and_b32 v133, s58, v106
    v_lshlrev_b32 v134, 16, v107
    v_and_b32 v135, s58, v107
    v_pk_add_f32 v[120:121], v[120:121], v[128:129]
    v_pk_add_f32 v[122:123], v[122:123], v[130:131]
    v_pk_add_f32 v[124:125], v[124:125], v[132:133]
    v_pk_add_f32 v[126:127], v[126:127], v[134:135]
    v_lshlrev_b32 v128, 16, v108
    v_and_b32 v129, s58, v108
    v_lshlrev_b32 v130, 16, v109
    v_and_b32 v131, s58, v109
    v_lshlrev_b32 v132, 16, v110
    v_and_b32 v133, s58, v110
    v_lshlrev_b32 v134, 16, v111
    v_and_b32 v135, s58, v111
    v_pk_add_f32 v[120:121], v[120:121], v[128:129]
    v_pk_add_f32 v[122:123], v[122:123], v[130:131]
    v_pk_add_f32 v[124:125], v[124:125], v[132:133]
    v_pk_add_f32 v[126:127], v[126:127], v[134:135]
    v_cvt_pk_bf16_f32 v136, v120, v121
    v_cvt_pk_bf16_f32 v137, v122, v123
    v_cvt_pk_bf16_f32 v138, v124, v125
    v_cvt_pk_bf16_f32 v139, v126, v127
    buffer_store_dwordx2 v[136:137], v41, s[16:19], 0 offen
    buffer_store_dwordx2 v[138:139], v41, s[16:19], 0 offen offset:32
    s_mov_b64 exec, -1
    s_branch L_fin
L_w7:
    s_lshl_b32 s3, s54, 4
    v_mov_b32 v42, s3
    v_lshlrev_b32 v43, 2, v2
    s_and_b32 s3, s7, 0
    s_lshl_b32 s3, s3, 8
    v_add_u32 v43, s3, v43
    s_mov_b32 s57, 0
L_poll0:
    global_load_dword v48, v42, s[62:63] sc1
    s_waitcnt vmcnt(0)
    v_readfirstlane_b32 s3, v48
    s_add_u32 s57, s57, 1
    s_cmp_ge_u32 s3, 16
    s_cbranch_scc1 L_poll0_done
    s_sleep 8
    s_cmp_lt_u32 s57, 0x20000
    s_cbranch_scc1 L_poll0
L_poll0_done:
L_cnt:
    ds_read_b32 v45, v12 offset:4
    s_waitcnt lgkmcnt(0)
    v_readfirstlane_b32 s3, v45
    s_add_u32 s57, s57, 1
    s_cmp_ge_u32 s3, 4
    s_cbranch_scc1 L_cnt_done
    s_sleep 1
    s_cmp_lt_u32 s57, 0x400000
    s_cbranch_scc1 L_cnt
L_cnt_done:
    s_mov_b64 exec, 0xffff
    global_load_dword v48, v43, s[32:33] sc1
    s_waitcnt vmcnt(0)
    v_cmp_eq_u32 vcc, 1, v48
    s_nop 1
    v_mov_b32 v47, vcc_lo
    ds_or_b32 v12, v47
L_own:
    ds_read_b32 v45, v12
    s_waitcnt lgkmcnt(0)
    v_readfirstlane_b32 s3, v45
    s_add_u32 s57, s57, 1
    s_bitcmp1_b32 s3, s7
    s_cbranch_scc1 L_own_done
    s_sleep 1
    s_cmp_lt_u32 s57, 0x400000
    s_cbranch_scc1 L_own
L_own_done:
    s_mov_b32 s57, 0
L_poll:
    global_load_dword v48, v43, s[32:33] sc1
    s_waitcnt vmcnt(0)
    v_cmp_eq_u32 vcc, 1, v48
    s_add_u32 s57, s57, 1
    s_nop 0
    v_mov_b32 v47, vcc_lo
    ds_or_b32 v12, v47
    s_cmp_eq_u32 vcc_lo, 0xffff
    s_cbranch_scc1 L_poll_done
    s_sleep 2
    s_cmp_lt_u32 s57, 0x20000
    s_cbranch_scc1 L_poll
L_poll_done:
    s_waitcnt lgkmcnt(0)
    s_mov_b64 exec, -1
L_fin:
L_end:
    s_endpgm
L_code_end:
.section .rodata,"a"
.p2align 6
.amdhsa_kernel concat_heads__mha_block_cached__mha_block_cached__near_ridge_kernel
  .amdhsa_next_free_vgpr 256
  .amdhsa_next_free_sgpr 102
  .amdhsa_accum_offset 256
  .amdhsa_group_segment_fixed_size 0
  .amdhsa_kernarg_size 104
  .amdhsa_user_sgpr_count 2
  .amdhsa_user_sgpr_kernarg_segment_ptr 1
  .amdhsa_system_sgpr_workgroup_id_x 1
.end_amdhsa_kernel
```
